```python
import torch

def _softmax(x, axis=-1):
    return torch.softmax(x, dim=axis)
def _gelu(x):
    return torch.nn.functional.gelu(x, approximate="tanh")
def _silu(x):
    return torch.nn.functional.silu(x)
def _sigmoid(x):
    return torch.sigmoid(x)
def _layernorm(x, axis=-1, eps=1e-5):
    m = x.mean(dim=axis, keepdim=True)
    v = x.var(dim=axis, keepdim=True, unbiased=False)
    return (x - m) / torch.sqrt(v + eps)
def _scatter_add(tgt, idx, src, axis=0):
    return tgt.clone().index_add_(axis, idx, src)
def _segment_sum(src, seg, n):
    out = torch.zeros((n,) + src.shape[1:], dtype=src.dtype)
    return out.index_add_(0, seg, src)
def _pad(x, pw):
    flat = tuple(v for pair in reversed(pw) for v in pair)
    return torch.nn.functional.pad(x, flat)

kernel_name = 'parallel_sum__gqa_block_cached__swiglu_ffn__decode'

def setup_inputs():

    _w = (lambda a: (lambda t: t.to(torch.bfloat16) if t.is_floating_point() else t)(torch.as_tensor(a)))
    def _A_setup():
        B, Sq, D = 1, 1, 576
        Hq, Hkv, Sk, Dh = 32, 16, 16384, 128
        assert Hq % Hkv == 0, (Hq, Hkv)
        return {
            "x": _w((lambda *s: torch.randn(*s, dtype=torch.bfloat16) * 0.05)(B, Sq, D)),
            "k_cache": _w((lambda *s: torch.randn(*s, dtype=torch.bfloat16) * 3.2)(B, Hkv, Sk, Dh)),
            "v_cache": _w((lambda *s: torch.randn(*s, dtype=torch.bfloat16) * 1.6)(B, Hkv, Sk, Dh)),
            "wq": _w((lambda *s: torch.randn(*s, dtype=torch.bfloat16) * 3.2)(D, Hq * Dh) * (D ** -0.5)),
            "wo": _w((lambda *s: torch.randn(*s, dtype=torch.bfloat16) * 1.6)(Hq * Dh, D) * ((Hq * Dh) ** -0.5)),
        }
    _A_in = _A_setup()

    def _B_setup():
        B, S, D, F = 1, 1, 576, 4608
        return {
            "x": _w((lambda *s: torch.randn(*s, dtype=torch.bfloat16) * 0.05)(B, S, D)),
            "w_gate": _w((lambda *s: torch.randn(*s, dtype=torch.bfloat16) * 0.05)(D, F)),
            "w_up": _w((lambda *s: torch.randn(*s, dtype=torch.bfloat16) * 0.05)(D, F)),
            "w_down": _w((lambda *s: torch.randn(*s, dtype=torch.bfloat16) * 0.05)(F, D)),
        }
    _B_in = _B_setup()

    return {
        "A_x": _A_in["x"],
        "A_k_cache": _A_in["k_cache"],
        "A_v_cache": _A_in["v_cache"],
        "A_wq": _A_in["wq"],
        "A_wo": _A_in["wo"],
        "B_x": _B_in["x"],
        "B_w_gate": _B_in["w_gate"],
        "B_w_up": _B_in["w_up"],
        "B_w_down": _B_in["w_down"],
    }

def reference(A_x, A_k_cache, A_v_cache, A_wq, A_wo, B_x, B_w_gate, B_w_up, B_w_down):
    def _A_ref(x, k_cache, v_cache, wq, wo):
        B, Sq, D = x.shape
        Hq, Dh = 32, 128
        Hkv = k_cache.shape[1]
        rep = Hq // Hkv
        q = (lambda x, *d: x.permute(*d))((x @ wq).reshape(B, Sq, Hq, Dh), 0, 2, 1, 3)
        k = (lambda x, n, axis: torch.repeat_interleave(x, n, dim=axis))(k_cache, rep, axis=1)
        v = (lambda x, n, axis: torch.repeat_interleave(x, n, dim=axis))(v_cache, rep, axis=1)
        scores = torch.einsum("bhqd,bhkd->bhqk", q, k) * (Dh ** -0.5)
        p = _softmax(scores, axis=-1)
        o = torch.einsum("bhqk,bhkd->bhqd", p, v)
        return (lambda x, *d: x.permute(*d))(o, 0, 2, 1, 3).reshape(B, Sq, Hq * Dh) @ wo

    def _B_ref(x, w_gate, w_up, w_down):
        g = _silu(x @ w_gate)
        u = x @ w_up
        return (g * u) @ w_down

    x = A_x
    xn = _layernorm(x, axis=-1)
    return x + _A_ref(xn, A_k_cache, A_v_cache, A_wq, A_wo) + _B_ref(xn, B_w_gate, B_w_up, B_w_down)
```

```asm
; @launch grid=(256,1,1) block=(320,1,1) lds=77824
.amdgcn_target "amdgcn-amd-amdhsa--gfx950"
.text
.p2align 8
L_tail_b:
    s_waitcnt vmcnt(6)
    v_perm_b32 v12, v73, v73, v4
    v_perm_b32 v13, v73, v73, v5
    v_mfma_f32_16x16x32_bf16 v[20:23], v[16:19], v[156:159], v[20:23]
    v_perm_b32 v14, v73, v73, v6
    v_perm_b32 v15, v73, v73, v7
    s_waitcnt vmcnt(5)
    v_perm_b32 v16, v73, v73, v8
    v_perm_b32 v17, v73, v73, v9
    v_mfma_f32_16x16x32_bf16 v[20:23], v[12:15], v[160:163], v[20:23]
    v_perm_b32 v18, v73, v73, v10
    v_perm_b32 v19, v73, v73, v11
    s_waitcnt vmcnt(4)
    v_perm_b32 v12, v74, v74, v4
    v_perm_b32 v13, v74, v74, v5
    v_mfma_f32_16x16x32_bf16 v[20:23], v[16:19], v[164:167], v[20:23]
    v_perm_b32 v14, v74, v74, v6
    v_perm_b32 v15, v74, v74, v7
    s_waitcnt vmcnt(3)
    v_perm_b32 v16, v74, v74, v8
    v_perm_b32 v17, v74, v74, v9
    v_mfma_f32_16x16x32_bf16 v[20:23], v[12:15], v[168:171], v[20:23]
    v_perm_b32 v18, v74, v74, v10
    v_perm_b32 v19, v74, v74, v11
    s_waitcnt vmcnt(2)
    v_perm_b32 v12, v75, v75, v4
    v_perm_b32 v13, v75, v75, v5
    v_mfma_f32_16x16x32_bf16 v[20:23], v[16:19], v[172:175], v[20:23]
    v_perm_b32 v14, v75, v75, v6
    v_perm_b32 v15, v75, v75, v7
    s_waitcnt vmcnt(1)
    v_perm_b32 v16, v75, v75, v8
    v_perm_b32 v17, v75, v75, v9
    v_mfma_f32_16x16x32_bf16 v[20:23], v[12:15], v[176:179], v[20:23]
    v_perm_b32 v18, v75, v75, v10
    v_perm_b32 v19, v75, v75, v11
    s_waitcnt vmcnt(0)
    s_nop 0
    v_mfma_f32_16x16x32_bf16 v[20:23], v[16:19], v[180:183], v[20:23]
    s_nop 7
    v_mul_f32 v20, v20, v94
    v_mul_f32 v21, v21, v94
    v_mul_f32 v22, v22, v94
    v_mul_f32 v23, v23, v94
    ds_write_b128 v95, v[20:23] offset:1024
    s_waitcnt lgkmcnt(0)
    s_barrier
    s_barrier
    s_cmp_lt_u32 s6, 12
    s_cbranch_scc0 L_nog
    buffer_load_dwordx4 v[24:27], v88, s[24:27], s51 offen sc1
    buffer_load_dwordx4 v[28:31], v88, s[24:27], s90 offen sc1
    s_mov_b32 s47, 0
    s_branch L_ob_wait
L_ob_again:
    buffer_load_dwordx4 v[24:27], v88, s[24:27], s51 offen sc1
    buffer_load_dwordx4 v[28:31], v88, s[24:27], s90 offen sc1
    s_add_u32 s47, s47, 1
    s_cmp_ge_u32 s47, 262144
    s_cbranch_scc1 L_ob_ok
L_ob_wait:
    s_waitcnt vmcnt(0)
    v_xor_b32 v24, s36, v24
    v_xor_b32 v25, s37, v25
    v_xor_b32 v26, s38, v26
    v_xor_b32 v27, s39, v27
    v_xor_b32 v28, s36, v28
    v_xor_b32 v29, s37, v29
    v_xor_b32 v30, s38, v30
    v_xor_b32 v31, s39, v31
    v_or3_b32 v76, v24, v25, v26
    v_or3_b32 v77, v28, v29, v30
    v_or3_b32 v76, v76, v27, v31
    v_or_b32 v76, v76, v77
    v_cmp_ne_u32_sdwa vcc, v76, v91 src0_sel:BYTE_0 src1_sel:DWORD
    v_pk_add_f32 v[24:25], v[24:25], v[28:29]
    v_pk_add_f32 v[26:27], v[26:27], v[30:31]
    s_mov_b64 exec, vcc
    s_cbranch_execnz L_ob_again
L_ob_ok:
    s_mov_b64 exec, -1
    v_permlane32_swap_b32 v24, v26
    v_permlane32_swap_b32 v25, v27
    v_pk_add_f32 v[24:25], v[24:25], v[26:27]
    s_nop 1
    v_permlane16_swap_b32 v24, v25
    v_add_f32 v24, v24, v25
    s_nop 1
    v_add_f32_dpp v24, v24, v24 row_ror:8 row_mask:0xf bank_mask:0xf
    v_cvt_pk_bf16_f32 v24, v24, v24
    ds_write_b16 v89, v24 offset:256
    s_waitcnt lgkmcnt(0)
    s_barrier
    s_endpgm
L_nog:
    s_cmp_lt_u32 s2, 240
    s_cbranch_scc1 L_fin2
    s_cmp_ge_u32 s2, 249
    s_cbranch_scc1 L_fin2
    s_mov_b32 s28, s64
    s_mov_b32 s29, s65
    s_mov_b32 s30, 1152
    s_mov_b32 s31, 0x20000
    s_mov_b32 s32, s82
    s_mov_b32 s33, s83
    s_mov_b32 s34, 1152
    s_mov_b32 s35, 0x20000
    s_sub_u32 s43, s2, 240
    s_lshl_b32 s43, s43, 2
    s_add_u32 s43, s43, s3
    s_lshr_b32 s44, s43, 1
    s_lshl_b32 s44, s44, 15
    s_and_b32 s45, s43, 1
    s_lshl_b32 s45, s45, 6
    s_add_u32 s44, s44, s45
    s_and_b32 s45, s43, 16
    s_lshl_b32 s45, s45, 9
    s_add_u32 s44, s44, s45
    s_add_u32 s44, s44, 524288
    s_xor_b32 s44, s44, s93
    v_lshrrev_b32 v76, 2, v0
    v_and_b32 v77, 3, v0
    v_lshlrev_b32 v76, 7, v76
    v_lshl_add_u32 v38, v77, 4, v76
    s_add_u32 s45, s44, 4096
    s_add_u32 s46, s44, 16384
    s_lshl_b32 s43, s43, 5
    v_bfe_u32 v76, v0, 3, 1
    v_lshl_or_b32 v76, v77, 1, v76
    v_bfe_u32 v77, v0, 4, 1
    v_lshl_or_b32 v76, v76, 1, v77
    v_lshl_add_u32 v37, v76, 1, s43
    buffer_load_ushort v36, v37, s[28:31], 0 offen
    s_waitcnt vmcnt(0)
    v_lshlrev_b32 v36, 16, v36
    s_mov_b32 s47, 0
L_ff_again:
    s_sleep 2
    buffer_load_dwordx4 v[44:47], v38, s[24:27], s44 offen offset:0 sc1
    buffer_load_dwordx4 v[48:51], v38, s[24:27], s44 offen offset:2048 sc1
    buffer_load_dwordx4 v[52:55], v38, s[24:27], s45 offen offset:0 sc1
    buffer_load_dwordx4 v[56:59], v38, s[24:27], s45 offen offset:2048 sc1
    buffer_load_dwordx4 v[60:63], v38, s[24:27], s46 offen offset:0 sc1
    s_add_u32 s47, s47, 1
    s_cmp_ge_u32 s47, 262144
    s_cbranch_scc1 L_ff_ok
    s_waitcnt vmcnt(0)
    v_xor_b32 v52, s36, v52
    v_xor_b32 v53, s37, v53
    v_xor_b32 v54, s38, v54
    v_xor_b32 v55, s39, v55
    v_xor_b32 v56, s36, v56
    v_xor_b32 v57, s37, v57
    v_xor_b32 v58, s38, v58
    v_xor_b32 v59, s39, v59
    v_xor_b32 v60, s36, v60
    v_xor_b32 v61, s37, v61
    v_xor_b32 v62, s38, v62
    v_xor_b32 v63, s39, v63
    v_or3_b32 v76, v52, v53, v54
    v_or3_b32 v77, v58, v59, v60
    v_or3_b32 v76, v76, v55, v56
    v_or3_b32 v77, v77, v61, v62
    v_or3_b32 v76, v76, v57, v63
    v_or_b32 v76, v76, v77
    v_cmp_ne_u32_sdwa vcc, v76, v91 src0_sel:BYTE_0 src1_sel:DWORD
    v_pk_add_f32 v[28:29], v[52:53], v[56:57]
    v_pk_add_f32 v[30:31], v[54:55], v[58:59]
    v_pk_add_f32 v[28:29], v[28:29], v[60:61]
    v_pk_add_f32 v[30:31], v[30:31], v[62:63]
    s_cbranch_vccnz L_ff_again
L_ff_ok:
    s_branch L_fa_chk
L_fa_again:
    buffer_load_dwordx4 v[44:47], v38, s[24:27], s44 offen offset:0 sc1
    buffer_load_dwordx4 v[48:51], v38, s[24:27], s44 offen offset:2048 sc1
    s_add_u32 s47, s47, 1
    s_cmp_ge_u32 s47, 262144
    s_cbranch_scc1 L_fa_ok
    s_waitcnt vmcnt(0)
L_fa_chk:
    v_xor_b32 v44, s36, v44
    v_xor_b32 v45, s37, v45
    v_xor_b32 v46, s38, v46
    v_xor_b32 v47, s39, v47
    v_xor_b32 v48, s36, v48
    v_xor_b32 v49, s37, v49
    v_xor_b32 v50, s38, v50
    v_xor_b32 v51, s39, v51
    v_or3_b32 v76, v44, v45, v46
    v_or3_b32 v77, v48, v49, v50
    v_or3_b32 v76, v76, v47, v51
    v_or_b32 v76, v76, v77
    v_cmp_ne_u32_sdwa vcc, v76, v91 src0_sel:BYTE_0 src1_sel:DWORD
    v_pk_add_f32 v[24:25], v[44:45], v[48:49]
    v_pk_add_f32 v[26:27], v[46:47], v[50:51]
    s_cbranch_vccnz L_fa_again
L_fa_ok:
    v_permlane32_swap_b32 v24, v28
    v_permlane32_swap_b32 v25, v29
    v_permlane32_swap_b32 v26, v30
    v_permlane32_swap_b32 v27, v31
    v_pk_add_f32 v[24:25], v[24:25], v[28:29]
    v_pk_add_f32 v[26:27], v[26:27], v[30:31]
    s_nop 0
    v_permlane16_swap_b32 v24, v25
    v_permlane16_swap_b32 v26, v27
    v_add_f32 v24, v24, v25
    v_add_f32 v26, v26, v27
    s_nop 0
    v_add_f32_dpp v25, v24, v24 row_ror:8 row_mask:0xf bank_mask:0x3
    s_nop 1
    v_add_f32_dpp v25, v26, v26 row_ror:8 row_mask:0xf bank_mask:0xc
    s_nop 1
    v_add_f32_dpp v24, v25, v25 row_shl:4 row_mask:0xf bank_mask:0x5
    v_cvt_pk_bf16_f32 v24, v24, v24
    v_and_b32 v24, 0xffff0000, v24
    v_add_f32 v26, v36, v24
    v_cvt_pk_bf16_f32 v26, v26, v26
    v_permlane32_swap_b32 v24, v25
    v_and_b32 v26, 0xffff0000, v26
    v_add_f32 v24, v26, v25
    v_cvt_pk_bf16_f32 v24, v24, v24
    s_mov_b64 exec, 0x0f0f0f0f
    buffer_store_short v24, v37, s[32:35], 0 offen
    s_cmp_eq_u32 s43, 0
    s_cbranch_scc0 L_fin2
    v_mov_b32 v25, s48
    s_mov_b64 exec, 1
    buffer_store_dword v25, v1, s[24:27], 0 offen
L_fin2:
    s_endpgm
.globl parallel_sum__gqa_block_cached__swiglu_ffn__decode_kernel
.p2align 8
.type parallel_sum__gqa_block_cached__swiglu_ffn__decode_kernel,@function
parallel_sum__gqa_block_cached__swiglu_ffn__decode_kernel:
    s_load_dwordx16 s[64:79], s[0:1], 0
    v_readfirstlane_b32 s3, v0
    s_cmpk_ge_u32 s2, 256
    s_cbranch_scc1 L_end
    s_and_b32 s4, s2, 15
    s_lshr_b32 s5, s2, 4
    s_cmpk_ge_u32 s3, 256
    s_cbranch_scc1 L_helper
    s_lshr_b32 s3, s3, 6
    s_and_b32 s43, s5, 3
    s_lshl2_add_u32 s43, s43, s3
    s_mul_i32 s43, s43, 36
    s_lshr_b32 s44, s5, 2
    s_lshl2_add_u32 s44, s4, s44
    s_lshl_b32 s45, s43, 6
    s_add_u32 s44, s44, s45
    s_lshl_b32 s44, s44, 7
    v_bfe_u32 v81, v0, 3, 3
    v_and_b32 v82, 7, v0
    v_lshlrev_b32 v82, 4, v82
    v_lshl_add_u32 v79, v81, 13, v82
    v_add_u32 v79, s44, v79
    s_mul_i32 s91, s3, 5120
    s_mov_b32 s18, 4718592
    s_mov_b32 s19, 0x20000
    s_bfe_u32 s44, s5, 0x10002
    s_add_u32 s43, s43, s44
    s_mul_i32 s43, s43, 72
    s_lshr_b32 s7, s5, 3
    s_and_b32 s44, s4, 7
    s_mul_i32 s44, s44, 9
    s_lshl2_add_u32 s44, s7, s44
    s_add_u32 s43, s43, s44
    s_lshl_b32 s43, s43, 7
    v_bfe_u32 v76, v0, 5, 1
    v_and_b32 v77, 31, v0
    v_mul_u32_u24 v76, 18432, v76
    v_lshl_add_u32 v76, v77, 4, v76
    v_add_u32 v76, s43, v76
    s_mul_i32 s92, s3, 9216
    s_mov_b32 s22, 5308416
    s_mov_b32 s23, 0x20000
    s_cmp_ge_u32 s4, 8
    s_waitcnt lgkmcnt(0)
    s_cselect_b32 s20, s78, s76
    s_cselect_b32 s21, s79, s77
    s_mov_b32 s16, s70
    s_mov_b32 s17, s71
    s_add_u32 m0, s91, 57344
    s_nop 0
    buffer_load_dwordx4 v79, s[16:19], 0 offen nt lds
    s_add_u32 m0, s92, 8192
    s_nop 0
    buffer_load_dwordx4 v76, s[20:23], 0 offen nt lds
    s_add_u32 m0, s91, 58368
    s_mov_b32 s41, 65536
    buffer_load_dwordx4 v79, s[16:19], s41 offen nt lds
    s_add_u32 m0, s92, 9216
    s_mov_b32 s41, 36864
    buffer_load_dwordx4 v76, s[20:23], s41 offen nt lds
    v_cmp_gt_u32 vcc, 4, v81
    v_mul_u32_u24 v77, 18432, v81
    v_mov_b32 v78, 2146435072
    v_cndmask_b32 v80, v78, v79, vcc
    v_cmp_gt_u32 vcc, 2, v81
    s_add_u32 s43, s43, 512
    v_add3_u32 v77, v77, v82, s43
    v_cndmask_b32 v78, v78, v77, vcc
    s_mul_i32 s93, s3, 3072
    s_mov_b32 s32, s20
    s_mov_b32 s33, s21
    s_mul_i32 s34, s7, 5308416
    s_mov_b32 s35, 0x20000
    s_add_u32 m0, s93, 45056
    s_nop 0
    buffer_load_dwordx4 v77, s[32:35], 0 offen nt lds
    s_add_u32 m0, s91, 59392
    s_mov_b32 s41, 131072
    buffer_load_dwordx4 v79, s[16:19], s41 offen nt lds
    s_getpc_b64 s[96:97]
L_pc:
    s_lshr_b32 s46, s2, 3
    s_lshl_b32 s46, s46, 10
    s_min_u32 s46, s46, L_end-L_tail_b-1020
    s_lshl_b32 s45, s3, 8
    s_add_u32 s46, s46, s45
    s_add_u32 s96, s96, s46
    s_addc_u32 s97, s97, 0
    s_sub_u32 s96, s96, L_pc-L_tail_b
    s_subb_u32 s97, s97, 0
    s_load_dword s94, s[96:97], 0
    s_load_dword s95, s[96:97], 64
    s_load_dword s94, s[96:97], 128
    s_load_dword s95, s[96:97], 192
    s_lshl4_add_u32 s43, s4, s5
    s_lshl_b32 s43, s43, 18
    s_bitcmp1_b32 s2, 4
    s_cselect_b32 s44, 327680, 0
    s_xor_b32 s43, s43, s44
    v_lshl_add_u32 v3, v0, 4, s43
    s_mov_b32 s8, s66
    s_mov_b32 s9, s67
    s_brev_b32 s10, 32
    s_mov_b32 s11, 0x20000
    s_waitcnt vmcnt(5)
    s_add_u32 m0, s92, 10240
    s_mov_b32 s41, 73728
    buffer_load_dwordx4 v76, s[20:23], s41 offen nt lds
    s_waitcnt vmcnt(5)
    s_add_u32 m0, s91, 60416
    s_mov_b32 s41, 196608
    buffer_load_dwordx4 v79, s[16:19], s41 offen nt lds
    s_waitcnt vmcnt(5)
    s_add_u32 m0, s92, 11264
    s_mov_b32 s41, 110592
    buffer_load_dwordx4 v76, s[20:23], s41 offen nt lds
    s_add_u32 m0, s93, 46080
    s_mov_b32 s41, 147456
    buffer_load_dwordx4 v77, s[32:35], s41 offen nt lds
    s_waitcnt vmcnt(6)
    s_add_u32 m0, s91, 61440
    s_mov_b32 s41, 262144
    buffer_load_dwordx4 v80, s[16:19], s41 offen nt lds
    s_waitcnt vmcnt(5)
    s_add_u32 m0, s92, 12288
    s_mov_b32 s41, 147456
    buffer_load_dwordx4 v76, s[20:23], s41 offen nt lds
    s_waitcnt vmcnt(5)
    s_add_u32 m0, s92, 13312
    s_mov_b32 s41, 184320
    buffer_load_dwordx4 v76, s[20:23], s41 offen nt lds
    s_add_u32 m0, s93, 47104
    s_mov_b32 s41, 294912
    buffer_load_dwordx4 v78, s[32:35], s41 offen nt lds
    s_waitcnt vmcnt(6)
    s_add_u32 m0, s92, 14336
    s_mov_b32 s41, 221184
    buffer_load_dwordx4 v76, s[20:23], s41 offen nt lds
    s_waitcnt vmcnt(6)
    s_add_u32 m0, s92, 15360
    s_mov_b32 s41, 258048
    buffer_load_dwordx4 v76, s[20:23], s41 offen nt lds
    s_waitcnt vmcnt(5)
    s_add_u32 m0, s92, 16384
    s_mov_b32 s41, 294912
    buffer_load_dwordx4 v76, s[20:23], s41 offen nt lds
    s_waitcnt vmcnt(5)
    buffer_load_dwordx4 v[44:47], v3, s[8:11], 0 offen nt
    s_waitcnt vmcnt(5)
    s_movk_i32 s41, 4096
    buffer_load_dwordx4 v[48:51], v3, s[8:11], s41 offen nt
    s_waitcnt vmcnt(4)
    s_movk_i32 s41, 8192
    buffer_load_dwordx4 v[52:55], v3, s[8:11], s41 offen nt
    s_barrier
    s_load_dwordx8 s[80:87], s[0:1], 64
    v_and_b32 v0, 63, v0
    v_lshlrev_b32 v1, 4, v0
    s_waitcnt vmcnt(4)
    s_movk_i32 s41, 12288
    buffer_load_dwordx4 v[56:59], v3, s[8:11], s41 offen nt
    s_waitcnt lgkmcnt(0)
    s_load_dword s40, s[86:87], 0
    s_mov_b32 s12, s68
    s_mov_b32 s13, s69
    s_mov_b32 s14, 67108864
    s_mov_b32 s15, 0x20000
    s_mov_b32 s24, s86
    s_mov_b32 s25, s87
    s_mov_b32 s26, 1507328
    s_mov_b32 s27, 0x20000
    s_waitcnt vmcnt(4)
    s_movk_i32 s41, 16384
    buffer_load_dwordx4 v[60:63], v3, s[8:11], s41 offen nt
    v_and_b32 v76, 1, v0
    v_cmp_eq_u32 vcc, 0, v76
    v_mov_b32 v77, 0x0c0c0100
    v_mov_b32 v78, 0x0c0c0302
    v_mov_b32 v79, 0x0c0c0c0c
    v_mov_b32 v4, 0x01000c0c
    v_mov_b32 v5, 0x03020c0c
    v_cndmask_b32 v77, v4, v77, vcc
    v_cndmask_b32 v78, v5, v78, vcc
    v_bfe_u32 v76, v0, 1, 2
    s_waitcnt vmcnt(4)
    s_movk_i32 s41, 20480
    buffer_load_dwordx4 v[64:67], v3, s[8:11], s41 offen nt
    v_mov_b32 v2, 0xffffff00
    v_cmp_eq_u32 vcc, 0, v76
    s_nop 1
    v_cndmask_b32 v4, v79, v77, vcc
    v_cndmask_b32 v8, v79, v78, vcc
    v_cmp_eq_u32 vcc, 1, v76
    s_nop 1
    v_cndmask_b32 v5, v79, v77, vcc
    v_cndmask_b32 v9, v79, v78, vcc
    v_cmp_eq_u32 vcc, 2, v76
    s_nop 1
    v_cndmask_b32 v6, v79, v77, vcc
    v_cndmask_b32 v10, v79, v78, vcc
    s_waitcnt vmcnt(4)
    s_movk_i32 s41, 24576
    buffer_load_dwordx4 v[68:71], v3, s[8:11], s41 offen nt
    v_cmp_eq_u32 vcc, 3, v76
    s_nop 1
    v_cndmask_b32 v7, v79, v77, vcc
    v_cndmask_b32 v11, v79, v78, vcc
    s_lshr_b32 s6, s2, 3
    s_mul_i32 s7, s6, 43
    s_lshr_b32 s7, s7, 7
    s_mul_i32 s43, s7, 3
    s_sub_u32 s46, s6, s43
    s_and_b32 s45, s2, 7
    s_lshr_b32 s43, s7, 1
    s_waitcnt vmcnt(4)
    s_movk_i32 s41, 28672
    buffer_load_dwordx4 v[72:75], v3, s[8:11], s41 offen nt
    s_lshl_b32 s43, s43, 3
    s_add_u32 s43, s43, s45
    s_lshl_b32 s43, s43, 1
    s_and_b32 s44, s7, 1
    s_add_u32 s43, s43, s44
    s_lshr_b32 s51, s43, 1
    s_lshl_b32 s51, s51, 14
    s_lshl_b32 s44, s44, 9
    s_add_u32 s51, s51, s44
    s_lshl_b32 s44, s3, 7
    s_waitcnt vmcnt(4)
    s_mov_b32 s41, 262144
    buffer_load_dwordx4 v[136:139], v3, s[8:11], s41 offen nt
    s_add_u32 s51, s51, s44
    s_add_u32 s51, s51, 262144
    s_add_u32 s90, s51, 8192
    s_mul_i32 s43, s43, 147456
    s_lshl_b32 s50, s45, 2
    s_add_u32 s50, s50, s7
    s_mul_i32 s45, s45, 6
    s_add_u32 s45, s45, s7
    s_sub_u32 s44, s45, 4
    s_mul_i32 s44, s44, 110592
    s_waitcnt vmcnt(4)
    s_mov_b32 s41, 266240
    buffer_load_dwordx4 v[140:143], v3, s[8:11], s41 offen nt
    s_add_u32 s45, s45, 28
    s_cmp_lt_u32 s7, 4
    s_cselect_b32 s43, s43, s44
    s_cselect_b32 s50, s50, s45
    s_cselect_b32 s20, s72, s80
    s_cselect_b32 s21, s73, s81
    s_mov_b32 s22, 5308416
    s_cselect_b32 s22, 4718592, s22
    s_cselect_b32 s45, 64, 48
    s_mov_b32 s23, 0x20000
    s_waitcnt vmcnt(4)
    s_mov_b32 s41, 270336
    buffer_load_dwordx4 v[144:147], v3, s[8:11], s41 offen nt
    s_mul_i32 s46, s46, 3
    s_add_u32 s46, s46, s3
    s_lshl_b32 s44, s46, 7
    s_add_u32 s43, s43, s44
    v_lshrrev_b32 v76, 3, v0
    v_and_b32 v77, 7, v0
    v_lshl_add_u32 v78, v77, 4, s43
    v_mov_b32 v79, 18432
    v_cmp_gt_u32 vcc, s45, v0
    v_mad_u32_u24 v96, v76, v79, v78
    s_waitcnt vmcnt(4)
    s_mov_b32 s41, 274432
    buffer_load_dwordx4 v[148:151], v3, s[8:11], s41 offen nt
    v_mov_b32 v79, 2146435072
    v_cndmask_b32 v96, v79, v96, vcc
    s_movk_i32 s16, 4608
    s_movk_i32 s17, 9216
    s_movk_i32 s18, 13824
    v_lshrrev_b32 v76, 5, v0
    v_bfe_u32 v77, v0, 3, 1
    v_lshl_or_b32 v76, v77, 1, v76
    v_bfe_u32 v77, v0, 2, 1
    v_lshl_or_b32 v77, v76, 1, v77
    s_waitcnt vmcnt(4)
    s_mov_b32 s41, 278528
    buffer_load_dwordx4 v[152:155], v3, s[8:11], s41 offen nt
    v_cmp_gt_u32 vcc, 1, v76
    v_and_b32 v76, 3, v0
    v_lshlrev_b32 v76, 5, v76
    v_and_or_b32 v76, v0, 16, v76
    v_lshl_or_b32 v76, v77, 15, v76
    v_mov_b32 v77, 2146435072
    v_cndmask_b32 v98, v77, v76, vcc
    s_and_b32 s44, s50, 64
    s_add_u32 s50, s50, s44
    s_and_b32 s44, s46, 4
    s_waitcnt vmcnt(4)
    s_mov_b32 s41, 282624
    buffer_load_dwordx4 v[156:159], v3, s[8:11], s41 offen nt
    s_lshl4_add_u32 s50, s44, s50
    s_lshl_b32 s50, s50, 7
    s_lshl_b32 s44, s46, 16
    s_add_u32 s50, s50, s44
    s_add_u32 s50, s50, 524288
    s_lshl_b32 s43, s3, 10
    v_add_u32 v95, s43, v1
    v_and_b32 v99, 15, v0
    v_lshlrev_b32 v99, 4, v99
    s_waitcnt vmcnt(4)
    s_mov_b32 s41, 286720
    buffer_load_dwordx4 v[160:163], v3, s[8:11], s41 offen nt
    v_and_b32 v76, 8, v0
    v_lshl_add_u32 v99, v76, 5, v99
    v_xor_b32 v100, 0x100, v99
    v_mov_b32 v92, 0xff800000
    v_lshrrev_b32 v76, 3, v0
    v_and_b32 v77, 7, v0
    v_lshlrev_b32 v76, 10, v76
    v_lshl_or_b32 v88, v77, 4, v76
    v_lshrrev_b32 v76, 4, v0
    v_lshlrev_b32 v77, 3, v77
    s_waitcnt vmcnt(4)
    s_mov_b32 s41, 290816
    buffer_load_dwordx4 v[164:167], v3, s[8:11], s41 offen nt
    v_lshl_or_b32 v77, v76, 1, v77
    s_lshl_b32 s43, s3, 6
    v_add_u32 v89, s43, v77
    v_and_b32 v77, 1, v0
    v_lshl_or_b32 v76, v76, 1, v77
    v_lshlrev_b32 v90, 5, v76
    v_mov_b32 v91, 0
    s_mov_b32 s88, 0x05040100
    s_mov_b32 s89, 0x07060302
    s_waitcnt lgkmcnt(0)
    s_waitcnt vmcnt(4)
    s_mov_b32 s41, 32768
    buffer_load_dwordx4 v[168:171], v3, s[8:11], s41 offen nt
    s_add_u32 s48, s40, 0x2b573b1d
    s_and_b32 s36, s48, 0xff
    s_bfe_u32 s37, s48, 0x80008
    s_bfe_u32 s38, s48, 0x80010
    s_lshr_b32 s39, s48, 24
    s_waitcnt vmcnt(4)
    s_mov_b32 s41, 36864
    buffer_load_dwordx4 v[172:175], v3, s[8:11], s41 offen nt
    s_waitcnt vmcnt(4)
    s_mov_b32 s41, 40960
    buffer_load_dwordx4 v[176:179], v3, s[8:11], s41 offen nt
    s_waitcnt vmcnt(4)
    s_mov_b32 s41, 45056
    buffer_load_dwordx4 v[180:183], v3, s[8:11], s41 offen nt
    s_waitcnt vmcnt(4)
    s_mov_b32 s41, 49152
    buffer_load_dwordx4 v[184:187], v3, s[8:11], s41 offen nt
    s_waitcnt vmcnt(4)
    s_mov_b32 s41, 53248
    buffer_load_dwordx4 v[188:191], v3, s[8:11], s41 offen nt
    s_waitcnt vmcnt(4)
    s_mov_b32 s41, 57344
    buffer_load_dwordx4 v[192:195], v3, s[8:11], s41 offen nt
    s_waitcnt vmcnt(4)
    s_mov_b32 s41, 61440
    buffer_load_dwordx4 v[196:199], v3, s[8:11], s41 offen nt
    s_waitcnt vmcnt(4)
    s_mov_b32 s41, 294912
    buffer_load_dwordx4 v[200:203], v3, s[8:11], s41 offen nt
    s_waitcnt vmcnt(4)
    s_mov_b32 s41, 299008
    buffer_load_dwordx4 v[204:207], v3, s[8:11], s41 offen nt
    s_waitcnt vmcnt(4)
    s_mov_b32 s41, 303104
    buffer_load_dwordx4 v[208:211], v3, s[8:11], s41 offen nt
    s_barrier
    ds_read_b128 v[36:39], v99 offset:512
    ds_read_b128 v[40:43], v100 offset:512
    s_waitcnt vmcnt(4)
    s_mov_b32 s41, 307200
    buffer_load_dwordx4 v[212:215], v3, s[8:11], s41 offen nt
    s_waitcnt lgkmcnt(0)
    v_dot2_f32_bf16 v76, v44, v36, 0
    v_dot2_f32_bf16 v77, v44, v40, 0
    v_dot2_f32_bf16 v78, v48, v36, 0
    v_dot2_f32_bf16 v79, v48, v40, 0
    v_dot2c_f32_bf16 v76, v45, v37
    v_dot2c_f32_bf16 v77, v45, v41
    v_dot2c_f32_bf16 v78, v49, v37
    v_dot2c_f32_bf16 v79, v49, v41
    v_dot2c_f32_bf16 v76, v46, v38
    v_dot2c_f32_bf16 v77, v46, v42
    v_dot2c_f32_bf16 v78, v50, v38
    v_dot2c_f32_bf16 v79, v50, v42
    v_dot2c_f32_bf16 v76, v47, v39
    v_dot2c_f32_bf16 v77, v47, v43
    v_dot2c_f32_bf16 v78, v51, v39
    v_dot2c_f32_bf16 v79, v51, v43
    s_waitcnt vmcnt(4)
    s_mov_b32 s41, 311296
    buffer_load_dwordx4 v[216:219], v3, s[8:11], s41 offen nt
    v_dot2_f32_bf16 v80, v52, v36, 0
    v_dot2_f32_bf16 v81, v52, v40, 0
    v_dot2_f32_bf16 v82, v56, v36, 0
    v_add_f32_dpp v76, v77, v76 row_ror:8 row_mask:0xf bank_mask:0xf
    v_dot2_f32_bf16 v83, v56, v40, 0
    v_add_f32_dpp v78, v79, v78 row_ror:8 row_mask:0xf bank_mask:0xf
    v_dot2c_f32_bf16 v80, v53, v37
    v_add_f32_dpp v76, v76, v76 quad_perm:[1,0,3,2] row_mask:0xf bank_mask:0xf
    v_dot2c_f32_bf16 v81, v53, v41
    v_add_f32_dpp v78, v78, v78 quad_perm:[1,0,3,2] row_mask:0xf bank_mask:0xf
    v_dot2c_f32_bf16 v82, v57, v37
    v_add_f32_dpp v76, v76, v76 quad_perm:[2,3,0,1] row_mask:0xf bank_mask:0xf
    v_dot2c_f32_bf16 v83, v57, v41
    v_add_f32_dpp v78, v78, v78 quad_perm:[2,3,0,1] row_mask:0xf bank_mask:0xf
    v_dot2c_f32_bf16 v80, v54, v38
    v_add_f32_dpp v76, v76, v76 row_half_mirror row_mask:0xf bank_mask:0xf
    v_dot2c_f32_bf16 v81, v54, v42
    v_add_f32_dpp v78, v78, v78 row_half_mirror row_mask:0xf bank_mask:0xf
    v_dot2c_f32_bf16 v82, v58, v38
    v_cvt_pk_bf16_f32 v77, v76, v78
    v_dot2c_f32_bf16 v83, v58, v42
    v_max3_f32 v92, v92, v76, v78
    v_dot2c_f32_bf16 v80, v55, v39
    v_lshlrev_b32 v76, 16, v77
    v_dot2c_f32_bf16 v81, v55, v43
    v_and_b32 v78, 0xffff0000, v77
    v_dot2c_f32_bf16 v82, v59, v39
    v_mul_f32 v76, 0x3db504f3, v76
    v_dot2c_f32_bf16 v83, v59, v43
    v_mul_f32 v78, 0x3db504f3, v78
    v_cvt_pk_bf16_f32 v44, v76, v78
    s_waitcnt vmcnt(4)
    s_mov_b32 s41, 315392
    buffer_load_dwordx4 v[220:223], v3, s[8:11], s41 offen nt
    v_dot2_f32_bf16 v76, v60, v36, 0
    v_dot2_f32_bf16 v77, v60, v40, 0
    v_dot2_f32_bf16 v78, v64, v36, 0
    v_add_f32_dpp v80, v81, v80 row_ror:8 row_mask:0xf bank_mask:0xf
    v_dot2_f32_bf16 v79, v64, v40, 0
    v_add_f32_dpp v82, v83, v82 row_ror:8 row_mask:0xf bank_mask:0xf
    v_dot2c_f32_bf16 v76, v61, v37
    v_add_f32_dpp v80, v80, v80 quad_perm:[1,0,3,2] row_mask:0xf bank_mask:0xf
    v_dot2c_f32_bf16 v77, v61, v41
    v_add_f32_dpp v82, v82, v82 quad_perm:[1,0,3,2] row_mask:0xf bank_mask:0xf
    v_dot2c_f32_bf16 v78, v65, v37
    v_add_f32_dpp v80, v80, v80 quad_perm:[2,3,0,1] row_mask:0xf bank_mask:0xf
    v_dot2c_f32_bf16 v79, v65, v41
    v_add_f32_dpp v82, v82, v82 quad_perm:[2,3,0,1] row_mask:0xf bank_mask:0xf
    v_dot2c_f32_bf16 v76, v62, v38
    v_add_f32_dpp v80, v80, v80 row_half_mirror row_mask:0xf bank_mask:0xf
    v_dot2c_f32_bf16 v77, v62, v42
    v_add_f32_dpp v82, v82, v82 row_half_mirror row_mask:0xf bank_mask:0xf
    v_dot2c_f32_bf16 v78, v66, v38
    v_cvt_pk_bf16_f32 v81, v80, v82
    v_dot2c_f32_bf16 v79, v66, v42
    v_max3_f32 v92, v92, v80, v82
    v_dot2c_f32_bf16 v76, v63, v39
    v_lshlrev_b32 v80, 16, v81
    v_dot2c_f32_bf16 v77, v63, v43
    v_and_b32 v82, 0xffff0000, v81
    v_dot2c_f32_bf16 v78, v67, v39
    v_mul_f32 v80, 0x3db504f3, v80
    v_dot2c_f32_bf16 v79, v67, v43
    v_mul_f32 v82, 0x3db504f3, v82
    v_cvt_pk_bf16_f32 v45, v80, v82
    s_waitcnt vmcnt(4)
    s_mov_b32 s41, 319488
    buffer_load_dwordx4 v[224:227], v3, s[8:11], s41 offen nt
    v_dot2_f32_bf16 v80, v68, v36, 0
    v_dot2_f32_bf16 v81, v68, v40, 0
    v_dot2_f32_bf16 v82, v72, v36, 0
    v_add_f32_dpp v76, v77, v76 row_ror:8 row_mask:0xf bank_mask:0xf
    v_dot2_f32_bf16 v83, v72, v40, 0
    v_add_f32_dpp v78, v79, v78 row_ror:8 row_mask:0xf bank_mask:0xf
    v_dot2c_f32_bf16 v80, v69, v37
    v_add_f32_dpp v76, v76, v76 quad_perm:[1,0,3,2] row_mask:0xf bank_mask:0xf
    v_dot2c_f32_bf16 v81, v69, v41
    v_add_f32_dpp v78, v78, v78 quad_perm:[1,0,3,2] row_mask:0xf bank_mask:0xf
    v_dot2c_f32_bf16 v82, v73, v37
    v_add_f32_dpp v76, v76, v76 quad_perm:[2,3,0,1] row_mask:0xf bank_mask:0xf
    v_dot2c_f32_bf16 v83, v73, v41
    v_add_f32_dpp v78, v78, v78 quad_perm:[2,3,0,1] row_mask:0xf bank_mask:0xf
    v_dot2c_f32_bf16 v80, v70, v38
    v_add_f32_dpp v76, v76, v76 row_half_mirror row_mask:0xf bank_mask:0xf
    v_dot2c_f32_bf16 v81, v70, v42
    v_add_f32_dpp v78, v78, v78 row_half_mirror row_mask:0xf bank_mask:0xf
    v_dot2c_f32_bf16 v82, v74, v38
    v_cvt_pk_bf16_f32 v77, v76, v78
    v_dot2c_f32_bf16 v83, v74, v42
    v_max3_f32 v92, v92, v76, v78
    v_dot2c_f32_bf16 v80, v71, v39
    v_lshlrev_b32 v76, 16, v77
    v_dot2c_f32_bf16 v81, v71, v43
    v_and_b32 v78, 0xffff0000, v77
    v_dot2c_f32_bf16 v82, v75, v39
    v_mul_f32 v76, 0x3db504f3, v76
    v_dot2c_f32_bf16 v83, v75, v43
    v_mul_f32 v78, 0x3db504f3, v78
    v_cvt_pk_bf16_f32 v46, v76, v78
    s_waitcnt vmcnt(4)
    s_mov_b32 s41, 323584
    buffer_load_dwordx4 v[228:231], v3, s[8:11], s41 offen nt
    v_dot2_f32_bf16 v76, v136, v36, 0
    v_dot2_f32_bf16 v77, v136, v40, 0
    v_dot2_f32_bf16 v78, v140, v36, 0
    v_add_f32_dpp v80, v81, v80 row_ror:8 row_mask:0xf bank_mask:0xf
    v_dot2_f32_bf16 v79, v140, v40, 0
    v_add_f32_dpp v82, v83, v82 row_ror:8 row_mask:0xf bank_mask:0xf
    v_dot2c_f32_bf16 v76, v137, v37
    v_add_f32_dpp v80, v80, v80 quad_perm:[1,0,3,2] row_mask:0xf bank_mask:0xf
    v_dot2c_f32_bf16 v77, v137, v41
    v_add_f32_dpp v82, v82, v82 quad_perm:[1,0,3,2] row_mask:0xf bank_mask:0xf
    v_dot2c_f32_bf16 v78, v141, v37
    v_add_f32_dpp v80, v80, v80 quad_perm:[2,3,0,1] row_mask:0xf bank_mask:0xf
    v_dot2c_f32_bf16 v79, v141, v41
    v_add_f32_dpp v82, v82, v82 quad_perm:[2,3,0,1] row_mask:0xf bank_mask:0xf
    v_dot2c_f32_bf16 v76, v138, v38
    v_add_f32_dpp v80, v80, v80 row_half_mirror row_mask:0xf bank_mask:0xf
    v_dot2c_f32_bf16 v77, v138, v42
    v_add_f32_dpp v82, v82, v82 row_half_mirror row_mask:0xf bank_mask:0xf
    v_dot2c_f32_bf16 v78, v142, v38
    v_cvt_pk_bf16_f32 v81, v80, v82
    v_dot2c_f32_bf16 v79, v142, v42
    v_max3_f32 v92, v92, v80, v82
    v_dot2c_f32_bf16 v76, v139, v39
    v_lshlrev_b32 v80, 16, v81
    v_dot2c_f32_bf16 v77, v139, v43
    v_and_b32 v82, 0xffff0000, v81
    v_dot2c_f32_bf16 v78, v143, v39
    v_mul_f32 v80, 0x3db504f3, v80
    v_dot2c_f32_bf16 v79, v143, v43
    v_mul_f32 v82, 0x3db504f3, v82
    v_cvt_pk_bf16_f32 v47, v80, v82
    s_waitcnt vmcnt(4)
    v_xor_b32 v3, 0x200000, v3
    s_mov_b32 s41, 131072
    buffer_load_dwordx4 v[232:235], v3, s[8:11], s41 offen nt
    v_dot2_f32_bf16 v80, v144, v36, 0
    v_dot2_f32_bf16 v81, v144, v40, 0
    v_dot2_f32_bf16 v82, v148, v36, 0
    v_add_f32_dpp v76, v77, v76 row_ror:8 row_mask:0xf bank_mask:0xf
    v_dot2_f32_bf16 v83, v148, v40, 0
    v_add_f32_dpp v78, v79, v78 row_ror:8 row_mask:0xf bank_mask:0xf
    v_dot2c_f32_bf16 v80, v145, v37
    v_add_f32_dpp v76, v76, v76 quad_perm:[1,0,3,2] row_mask:0xf bank_mask:0xf
    v_dot2c_f32_bf16 v81, v145, v41
    v_add_f32_dpp v78, v78, v78 quad_perm:[1,0,3,2] row_mask:0xf bank_mask:0xf
    v_dot2c_f32_bf16 v82, v149, v37
    v_add_f32_dpp v76, v76, v76 quad_perm:[2,3,0,1] row_mask:0xf bank_mask:0xf
    v_dot2c_f32_bf16 v83, v149, v41
    v_add_f32_dpp v78, v78, v78 quad_perm:[2,3,0,1] row_mask:0xf bank_mask:0xf
    v_dot2c_f32_bf16 v80, v146, v38
    v_add_f32_dpp v76, v76, v76 row_half_mirror row_mask:0xf bank_mask:0xf
    v_dot2c_f32_bf16 v81, v146, v42
    v_add_f32_dpp v78, v78, v78 row_half_mirror row_mask:0xf bank_mask:0xf
    v_dot2c_f32_bf16 v82, v150, v38
    v_cvt_pk_bf16_f32 v77, v76, v78
    v_dot2c_f32_bf16 v83, v150, v42
    v_max3_f32 v92, v92, v76, v78
    v_dot2c_f32_bf16 v80, v147, v39
    v_lshlrev_b32 v76, 16, v77
    v_dot2c_f32_bf16 v81, v147, v43
    v_and_b32 v78, 0xffff0000, v77
    v_dot2c_f32_bf16 v82, v151, v39
    v_mul_f32 v76, 0x3db504f3, v76
    v_dot2c_f32_bf16 v83, v151, v43
    v_mul_f32 v78, 0x3db504f3, v78
    v_cvt_pk_bf16_f32 v48, v76, v78
    s_waitcnt vmcnt(4)
    s_mov_b32 s41, 135168
    buffer_load_dwordx4 v[236:239], v3, s[8:11], s41 offen nt
    v_dot2_f32_bf16 v76, v152, v36, 0
    v_dot2_f32_bf16 v77, v152, v40, 0
    v_dot2_f32_bf16 v78, v156, v36, 0
    v_add_f32_dpp v80, v81, v80 row_ror:8 row_mask:0xf bank_mask:0xf
    v_dot2_f32_bf16 v79, v156, v40, 0
    v_add_f32_dpp v82, v83, v82 row_ror:8 row_mask:0xf bank_mask:0xf
    v_dot2c_f32_bf16 v76, v153, v37
    v_add_f32_dpp v80, v80, v80 quad_perm:[1,0,3,2] row_mask:0xf bank_mask:0xf
    v_dot2c_f32_bf16 v77, v153, v41
    v_add_f32_dpp v82, v82, v82 quad_perm:[1,0,3,2] row_mask:0xf bank_mask:0xf
    v_dot2c_f32_bf16 v78, v157, v37
    v_add_f32_dpp v80, v80, v80 quad_perm:[2,3,0,1] row_mask:0xf bank_mask:0xf
    v_dot2c_f32_bf16 v79, v157, v41
    v_add_f32_dpp v82, v82, v82 quad_perm:[2,3,0,1] row_mask:0xf bank_mask:0xf
    v_dot2c_f32_bf16 v76, v154, v38
    v_add_f32_dpp v80, v80, v80 row_half_mirror row_mask:0xf bank_mask:0xf
    v_dot2c_f32_bf16 v77, v154, v42
    v_add_f32_dpp v82, v82, v82 row_half_mirror row_mask:0xf bank_mask:0xf
    v_dot2c_f32_bf16 v78, v158, v38
    v_cvt_pk_bf16_f32 v81, v80, v82
    v_dot2c_f32_bf16 v79, v158, v42
    v_max3_f32 v92, v92, v80, v82
    v_dot2c_f32_bf16 v76, v155, v39
    v_lshlrev_b32 v80, 16, v81
    v_dot2c_f32_bf16 v77, v155, v43
    v_and_b32 v82, 0xffff0000, v81
    v_dot2c_f32_bf16 v78, v159, v39
    v_mul_f32 v80, 0x3db504f3, v80
    v_dot2c_f32_bf16 v79, v159, v43
    v_mul_f32 v82, 0x3db504f3, v82
    v_cvt_pk_bf16_f32 v49, v80, v82
    s_waitcnt vmcnt(4)
    s_mov_b32 s41, 139264
    buffer_load_dwordx4 v[240:243], v3, s[8:11], s41 offen nt
    v_dot2_f32_bf16 v80, v160, v36, 0
    v_dot2_f32_bf16 v81, v160, v40, 0
    v_dot2_f32_bf16 v82, v164, v36, 0
    v_add_f32_dpp v76, v77, v76 row_ror:8 row_mask:0xf bank_mask:0xf
    v_dot2_f32_bf16 v83, v164, v40, 0
    v_add_f32_dpp v78, v79, v78 row_ror:8 row_mask:0xf bank_mask:0xf
    v_dot2c_f32_bf16 v80, v161, v37
    v_add_f32_dpp v76, v76, v76 quad_perm:[1,0,3,2] row_mask:0xf bank_mask:0xf
    v_dot2c_f32_bf16 v81, v161, v41
    v_add_f32_dpp v78, v78, v78 quad_perm:[1,0,3,2] row_mask:0xf bank_mask:0xf
    v_dot2c_f32_bf16 v82, v165, v37
    v_add_f32_dpp v76, v76, v76 quad_perm:[2,3,0,1] row_mask:0xf bank_mask:0xf
    v_dot2c_f32_bf16 v83, v165, v41
    v_add_f32_dpp v78, v78, v78 quad_perm:[2,3,0,1] row_mask:0xf bank_mask:0xf
    v_dot2c_f32_bf16 v80, v162, v38
    v_add_f32_dpp v76, v76, v76 row_half_mirror row_mask:0xf bank_mask:0xf
    v_dot2c_f32_bf16 v81, v162, v42
    v_add_f32_dpp v78, v78, v78 row_half_mirror row_mask:0xf bank_mask:0xf
    v_dot2c_f32_bf16 v82, v166, v38
    v_cvt_pk_bf16_f32 v77, v76, v78
    v_dot2c_f32_bf16 v83, v166, v42
    v_max3_f32 v92, v92, v76, v78
    v_dot2c_f32_bf16 v80, v163, v39
    v_lshlrev_b32 v76, 16, v77
    v_dot2c_f32_bf16 v81, v163, v43
    v_and_b32 v78, 0xffff0000, v77
    v_dot2c_f32_bf16 v82, v167, v39
    v_mul_f32 v76, 0x3db504f3, v76
    v_dot2c_f32_bf16 v83, v167, v43
    v_mul_f32 v78, 0x3db504f3, v78
    v_cvt_pk_bf16_f32 v50, v76, v78
    s_waitcnt vmcnt(4)
    ds_read_b32 v101, v91 offset:96
    s_mov_b32 s41, 143360
    buffer_load_dwordx4 v[244:247], v3, s[8:11], s41 offen nt
    v_dot2_f32_bf16 v76, v168, v36, 0
    v_dot2_f32_bf16 v77, v168, v40, 0
    v_dot2_f32_bf16 v78, v172, v36, 0
    v_add_f32_dpp v80, v81, v80 row_ror:8 row_mask:0xf bank_mask:0xf
    v_dot2_f32_bf16 v79, v172, v40, 0
    v_add_f32_dpp v82, v83, v82 row_ror:8 row_mask:0xf bank_mask:0xf
    v_dot2c_f32_bf16 v76, v169, v37
    v_add_f32_dpp v80, v80, v80 quad_perm:[1,0,3,2] row_mask:0xf bank_mask:0xf
    v_dot2c_f32_bf16 v77, v169, v41
    v_add_f32_dpp v82, v82, v82 quad_perm:[1,0,3,2] row_mask:0xf bank_mask:0xf
    v_dot2c_f32_bf16 v78, v173, v37
    v_add_f32_dpp v80, v80, v80 quad_perm:[2,3,0,1] row_mask:0xf bank_mask:0xf
    v_dot2c_f32_bf16 v79, v173, v41
    v_add_f32_dpp v82, v82, v82 quad_perm:[2,3,0,1] row_mask:0xf bank_mask:0xf
    v_dot2c_f32_bf16 v76, v170, v38
    v_add_f32_dpp v80, v80, v80 row_half_mirror row_mask:0xf bank_mask:0xf
    v_dot2c_f32_bf16 v77, v170, v42
    v_add_f32_dpp v82, v82, v82 row_half_mirror row_mask:0xf bank_mask:0xf
    v_dot2c_f32_bf16 v78, v174, v38
    v_cvt_pk_bf16_f32 v81, v80, v82
    v_dot2c_f32_bf16 v79, v174, v42
    v_max3_f32 v92, v92, v80, v82
    v_dot2c_f32_bf16 v76, v171, v39
    v_lshlrev_b32 v80, 16, v81
    v_dot2c_f32_bf16 v77, v171, v43
    v_and_b32 v82, 0xffff0000, v81
    v_dot2c_f32_bf16 v78, v175, v39
    v_mul_f32 v80, 0x3db504f3, v80
    v_dot2c_f32_bf16 v79, v175, v43
    v_mul_f32 v82, 0x3db504f3, v82
    v_cvt_pk_bf16_f32 v51, v80, v82
    s_waitcnt vmcnt(4)
    s_waitcnt lgkmcnt(0)
    v_readfirstlane_b32 s42, v101
    s_mov_b32 s41, 147456
    buffer_load_dwordx4 v[104:107], v3, s[8:11], s41 offen nt
    v_dot2_f32_bf16 v80, v176, v36, 0
    v_dot2_f32_bf16 v81, v176, v40, 0
    v_dot2_f32_bf16 v82, v180, v36, 0
    v_add_f32_dpp v76, v77, v76 row_ror:8 row_mask:0xf bank_mask:0xf
    v_dot2_f32_bf16 v83, v180, v40, 0
    v_add_f32_dpp v78, v79, v78 row_ror:8 row_mask:0xf bank_mask:0xf
    v_dot2c_f32_bf16 v80, v177, v37
    v_add_f32_dpp v76, v76, v76 quad_perm:[1,0,3,2] row_mask:0xf bank_mask:0xf
    v_dot2c_f32_bf16 v81, v177, v41
    v_add_f32_dpp v78, v78, v78 quad_perm:[1,0,3,2] row_mask:0xf bank_mask:0xf
    v_dot2c_f32_bf16 v82, v181, v37
    v_add_f32_dpp v76, v76, v76 quad_perm:[2,3,0,1] row_mask:0xf bank_mask:0xf
    v_dot2c_f32_bf16 v83, v181, v41
    v_add_f32_dpp v78, v78, v78 quad_perm:[2,3,0,1] row_mask:0xf bank_mask:0xf
    v_dot2c_f32_bf16 v80, v178, v38
    v_add_f32_dpp v76, v76, v76 row_half_mirror row_mask:0xf bank_mask:0xf
    v_dot2c_f32_bf16 v81, v178, v42
    v_add_f32_dpp v78, v78, v78 row_half_mirror row_mask:0xf bank_mask:0xf
    v_dot2c_f32_bf16 v82, v182, v38
    v_cvt_pk_bf16_f32 v77, v76, v78
    v_dot2c_f32_bf16 v83, v182, v42
    v_max3_f32 v92, v92, v76, v78
    v_dot2c_f32_bf16 v80, v179, v39
    v_lshlrev_b32 v76, 16, v77
    v_dot2c_f32_bf16 v81, v179, v43
    v_and_b32 v78, 0xffff0000, v77
    v_dot2c_f32_bf16 v82, v183, v39
    v_mul_f32 v76, 0x3db504f3, v76
    v_dot2c_f32_bf16 v83, v183, v43
    v_mul_f32 v78, 0x3db504f3, v78
    v_cvt_pk_bf16_f32 v52, v76, v78
    s_cmpk_gt_u32 s42, 37
    s_cbranch_scc1 L_cu37
    s_waitcnt vmcnt(4)
L_cu37:
    s_mov_b32 s41, 151552
    buffer_load_dwordx4 v[108:111], v3, s[8:11], s41 offen nt
    v_dot2_f32_bf16 v76, v184, v36, 0
    v_dot2_f32_bf16 v77, v184, v40, 0
    v_dot2_f32_bf16 v78, v188, v36, 0
    v_add_f32_dpp v80, v81, v80 row_ror:8 row_mask:0xf bank_mask:0xf
    v_dot2_f32_bf16 v79, v188, v40, 0
    v_add_f32_dpp v82, v83, v82 row_ror:8 row_mask:0xf bank_mask:0xf
    v_dot2c_f32_bf16 v76, v185, v37
    v_add_f32_dpp v80, v80, v80 quad_perm:[1,0,3,2] row_mask:0xf bank_mask:0xf
    v_dot2c_f32_bf16 v77, v185, v41
    v_add_f32_dpp v82, v82, v82 quad_perm:[1,0,3,2] row_mask:0xf bank_mask:0xf
    v_dot2c_f32_bf16 v78, v189, v37
    v_add_f32_dpp v80, v80, v80 quad_perm:[2,3,0,1] row_mask:0xf bank_mask:0xf
    v_dot2c_f32_bf16 v79, v189, v41
    v_add_f32_dpp v82, v82, v82 quad_perm:[2,3,0,1] row_mask:0xf bank_mask:0xf
    v_dot2c_f32_bf16 v76, v186, v38
    v_add_f32_dpp v80, v80, v80 row_half_mirror row_mask:0xf bank_mask:0xf
    v_dot2c_f32_bf16 v77, v186, v42
    v_add_f32_dpp v82, v82, v82 row_half_mirror row_mask:0xf bank_mask:0xf
    v_dot2c_f32_bf16 v78, v190, v38
    v_cvt_pk_bf16_f32 v81, v80, v82
    v_dot2c_f32_bf16 v79, v190, v42
    v_max3_f32 v92, v92, v80, v82
    v_dot2c_f32_bf16 v76, v187, v39
    v_lshlrev_b32 v80, 16, v81
    v_dot2c_f32_bf16 v77, v187, v43
    v_and_b32 v82, 0xffff0000, v81
    v_dot2c_f32_bf16 v78, v191, v39
    v_mul_f32 v80, 0x3db504f3, v80
    v_dot2c_f32_bf16 v79, v191, v43
    v_mul_f32 v82, 0x3db504f3, v82
    v_cvt_pk_bf16_f32 v53, v80, v82
    s_cmpk_gt_u32 s42, 38
    s_cbranch_scc1 L_cu38
    s_waitcnt vmcnt(4)
L_cu38:
    s_mov_b32 s41, 155648
    buffer_load_dwordx4 v[112:115], v3, s[8:11], s41 offen nt
    v_dot2_f32_bf16 v80, v192, v36, 0
    v_dot2_f32_bf16 v81, v192, v40, 0
    v_dot2_f32_bf16 v82, v196, v36, 0
    v_add_f32_dpp v76, v77, v76 row_ror:8 row_mask:0xf bank_mask:0xf
    v_dot2_f32_bf16 v83, v196, v40, 0
    v_add_f32_dpp v78, v79, v78 row_ror:8 row_mask:0xf bank_mask:0xf
    v_dot2c_f32_bf16 v80, v193, v37
    v_add_f32_dpp v76, v76, v76 quad_perm:[1,0,3,2] row_mask:0xf bank_mask:0xf
    v_dot2c_f32_bf16 v81, v193, v41
    v_add_f32_dpp v78, v78, v78 quad_perm:[1,0,3,2] row_mask:0xf bank_mask:0xf
    v_dot2c_f32_bf16 v82, v197, v37
    v_add_f32_dpp v76, v76, v76 quad_perm:[2,3,0,1] row_mask:0xf bank_mask:0xf
    v_dot2c_f32_bf16 v83, v197, v41
    v_add_f32_dpp v78, v78, v78 quad_perm:[2,3,0,1] row_mask:0xf bank_mask:0xf
    v_dot2c_f32_bf16 v80, v194, v38
    v_add_f32_dpp v76, v76, v76 row_half_mirror row_mask:0xf bank_mask:0xf
    v_dot2c_f32_bf16 v81, v194, v42
    v_add_f32_dpp v78, v78, v78 row_half_mirror row_mask:0xf bank_mask:0xf
    v_dot2c_f32_bf16 v82, v198, v38
    v_cvt_pk_bf16_f32 v77, v76, v78
    v_dot2c_f32_bf16 v83, v198, v42
    v_max3_f32 v92, v92, v76, v78
    v_dot2c_f32_bf16 v80, v195, v39
    v_lshlrev_b32 v76, 16, v77
    v_dot2c_f32_bf16 v81, v195, v43
    v_and_b32 v78, 0xffff0000, v77
    v_dot2c_f32_bf16 v82, v199, v39
    v_mul_f32 v76, 0x3db504f3, v76
    v_dot2c_f32_bf16 v83, v199, v43
    v_mul_f32 v78, 0x3db504f3, v78
    v_cvt_pk_bf16_f32 v54, v76, v78
    s_waitcnt vmcnt(6)
    ds_read_b32 v101, v91 offset:96
    s_cmpk_gt_u32 s42, 39
    s_cbranch_scc1 L_cu39
    s_waitcnt vmcnt(4)
L_cu39:
    s_mov_b32 s41, 159744
    buffer_load_dwordx4 v[116:119], v3, s[8:11], s41 offen nt
    v_dot2_f32_bf16 v76, v200, v36, 0
    v_dot2_f32_bf16 v77, v200, v40, 0
    v_dot2_f32_bf16 v78, v204, v36, 0
    v_add_f32_dpp v80, v81, v80 row_ror:8 row_mask:0xf bank_mask:0xf
    v_dot2_f32_bf16 v79, v204, v40, 0
    v_add_f32_dpp v82, v83, v82 row_ror:8 row_mask:0xf bank_mask:0xf
    v_dot2c_f32_bf16 v76, v201, v37
    v_add_f32_dpp v80, v80, v80 quad_perm:[1,0,3,2] row_mask:0xf bank_mask:0xf
    v_dot2c_f32_bf16 v77, v201, v41
    v_add_f32_dpp v82, v82, v82 quad_perm:[1,0,3,2] row_mask:0xf bank_mask:0xf
    v_dot2c_f32_bf16 v78, v205, v37
    v_add_f32_dpp v80, v80, v80 quad_perm:[2,3,0,1] row_mask:0xf bank_mask:0xf
    v_dot2c_f32_bf16 v79, v205, v41
    v_add_f32_dpp v82, v82, v82 quad_perm:[2,3,0,1] row_mask:0xf bank_mask:0xf
    v_dot2c_f32_bf16 v76, v202, v38
    v_add_f32_dpp v80, v80, v80 row_half_mirror row_mask:0xf bank_mask:0xf
    v_dot2c_f32_bf16 v77, v202, v42
    v_add_f32_dpp v82, v82, v82 row_half_mirror row_mask:0xf bank_mask:0xf
    v_dot2c_f32_bf16 v78, v206, v38
    v_cvt_pk_bf16_f32 v81, v80, v82
    v_dot2c_f32_bf16 v79, v206, v42
    v_max3_f32 v92, v92, v80, v82
    v_dot2c_f32_bf16 v76, v203, v39
    v_lshlrev_b32 v80, 16, v81
    v_dot2c_f32_bf16 v77, v203, v43
    v_and_b32 v82, 0xffff0000, v81
    v_dot2c_f32_bf16 v78, v207, v39
    v_mul_f32 v80, 0x3db504f3, v80
    v_dot2c_f32_bf16 v79, v207, v43
    v_mul_f32 v82, 0x3db504f3, v82
    v_cvt_pk_bf16_f32 v55, v80, v82
    s_waitcnt vmcnt(6)
    s_waitcnt lgkmcnt(0)
    v_readfirstlane_b32 s42, v101
    s_nop 0
    s_cmpk_gt_u32 s42, 40
    s_cbranch_scc1 L_cu40
    s_waitcnt vmcnt(4)
L_cu40:
    s_mov_b32 s41, 393216
    buffer_load_dwordx4 v[120:123], v3, s[8:11], s41 offen nt
    v_dot2_f32_bf16 v80, v208, v36, 0
    v_dot2_f32_bf16 v81, v208, v40, 0
    v_dot2_f32_bf16 v82, v212, v36, 0
    v_add_f32_dpp v76, v77, v76 row_ror:8 row_mask:0xf bank_mask:0xf
    v_dot2_f32_bf16 v83, v212, v40, 0
    v_add_f32_dpp v78, v79, v78 row_ror:8 row_mask:0xf bank_mask:0xf
    v_dot2c_f32_bf16 v80, v209, v37
    v_add_f32_dpp v76, v76, v76 quad_perm:[1,0,3,2] row_mask:0xf bank_mask:0xf
    v_dot2c_f32_bf16 v81, v209, v41
    v_add_f32_dpp v78, v78, v78 quad_perm:[1,0,3,2] row_mask:0xf bank_mask:0xf
    v_dot2c_f32_bf16 v82, v213, v37
    v_add_f32_dpp v76, v76, v76 quad_perm:[2,3,0,1] row_mask:0xf bank_mask:0xf
    v_dot2c_f32_bf16 v83, v213, v41
    v_add_f32_dpp v78, v78, v78 quad_perm:[2,3,0,1] row_mask:0xf bank_mask:0xf
    v_dot2c_f32_bf16 v80, v210, v38
    v_add_f32_dpp v76, v76, v76 row_half_mirror row_mask:0xf bank_mask:0xf
    v_dot2c_f32_bf16 v81, v210, v42
    v_add_f32_dpp v78, v78, v78 row_half_mirror row_mask:0xf bank_mask:0xf
    v_dot2c_f32_bf16 v82, v214, v38
    v_cvt_pk_bf16_f32 v77, v76, v78
    v_dot2c_f32_bf16 v83, v214, v42
    v_max3_f32 v92, v92, v76, v78
    v_dot2c_f32_bf16 v80, v211, v39
    v_lshlrev_b32 v76, 16, v77
    v_dot2c_f32_bf16 v81, v211, v43
    v_and_b32 v78, 0xffff0000, v77
    v_dot2c_f32_bf16 v82, v215, v39
    v_mul_f32 v76, 0x3db504f3, v76
    v_dot2c_f32_bf16 v83, v215, v43
    v_mul_f32 v78, 0x3db504f3, v78
    v_cvt_pk_bf16_f32 v56, v76, v78
    s_waitcnt vmcnt(6)
    s_cmpk_gt_u32 s42, 41
    s_cbranch_scc1 L_cu41
    s_waitcnt vmcnt(4)
L_cu41:
    s_mov_b32 s41, 397312
    buffer_load_dwordx4 v[124:127], v3, s[8:11], s41 offen nt
    v_dot2_f32_bf16 v76, v216, v36, 0
    v_dot2_f32_bf16 v77, v216, v40, 0
    v_dot2_f32_bf16 v78, v220, v36, 0
    v_add_f32_dpp v80, v81, v80 row_ror:8 row_mask:0xf bank_mask:0xf
    v_dot2_f32_bf16 v79, v220, v40, 0
    v_add_f32_dpp v82, v83, v82 row_ror:8 row_mask:0xf bank_mask:0xf
    v_dot2c_f32_bf16 v76, v217, v37
    v_add_f32_dpp v80, v80, v80 quad_perm:[1,0,3,2] row_mask:0xf bank_mask:0xf
    v_dot2c_f32_bf16 v77, v217, v41
    v_add_f32_dpp v82, v82, v82 quad_perm:[1,0,3,2] row_mask:0xf bank_mask:0xf
    v_dot2c_f32_bf16 v78, v221, v37
    v_add_f32_dpp v80, v80, v80 quad_perm:[2,3,0,1] row_mask:0xf bank_mask:0xf
    v_dot2c_f32_bf16 v79, v221, v41
    v_add_f32_dpp v82, v82, v82 quad_perm:[2,3,0,1] row_mask:0xf bank_mask:0xf
    v_dot2c_f32_bf16 v76, v218, v38
    v_add_f32_dpp v80, v80, v80 row_half_mirror row_mask:0xf bank_mask:0xf
    v_dot2c_f32_bf16 v77, v218, v42
    v_add_f32_dpp v82, v82, v82 row_half_mirror row_mask:0xf bank_mask:0xf
    v_dot2c_f32_bf16 v78, v222, v38
    v_cvt_pk_bf16_f32 v81, v80, v82
    v_dot2c_f32_bf16 v79, v222, v42
    v_max3_f32 v92, v92, v80, v82
    v_dot2c_f32_bf16 v76, v219, v39
    v_lshlrev_b32 v80, 16, v81
    v_dot2c_f32_bf16 v77, v219, v43
    v_and_b32 v82, 0xffff0000, v81
    v_dot2c_f32_bf16 v78, v223, v39
    v_mul_f32 v80, 0x3db504f3, v80
    v_dot2c_f32_bf16 v79, v223, v43
    v_mul_f32 v82, 0x3db504f3, v82
    v_cvt_pk_bf16_f32 v57, v80, v82
    s_waitcnt vmcnt(6)
    s_cmpk_gt_u32 s42, 42
    s_cbranch_scc1 L_cu42
    s_waitcnt vmcnt(4)
L_cu42:
    s_mov_b32 s41, 401408
    buffer_load_dwordx4 v[128:131], v3, s[8:11], s41 offen nt
    v_dot2_f32_bf16 v80, v224, v36, 0
    v_dot2_f32_bf16 v81, v224, v40, 0
    v_dot2_f32_bf16 v82, v228, v36, 0
    v_add_f32_dpp v76, v77, v76 row_ror:8 row_mask:0xf bank_mask:0xf
    v_dot2_f32_bf16 v83, v228, v40, 0
    v_add_f32_dpp v78, v79, v78 row_ror:8 row_mask:0xf bank_mask:0xf
    v_dot2c_f32_bf16 v80, v225, v37
    v_add_f32_dpp v76, v76, v76 quad_perm:[1,0,3,2] row_mask:0xf bank_mask:0xf
    v_dot2c_f32_bf16 v81, v225, v41
    v_add_f32_dpp v78, v78, v78 quad_perm:[1,0,3,2] row_mask:0xf bank_mask:0xf
    v_dot2c_f32_bf16 v82, v229, v37
    v_add_f32_dpp v76, v76, v76 quad_perm:[2,3,0,1] row_mask:0xf bank_mask:0xf
    v_dot2c_f32_bf16 v83, v229, v41
    v_add_f32_dpp v78, v78, v78 quad_perm:[2,3,0,1] row_mask:0xf bank_mask:0xf
    v_dot2c_f32_bf16 v80, v226, v38
    v_add_f32_dpp v76, v76, v76 row_half_mirror row_mask:0xf bank_mask:0xf
    v_dot2c_f32_bf16 v81, v226, v42
    v_add_f32_dpp v78, v78, v78 row_half_mirror row_mask:0xf bank_mask:0xf
    v_dot2c_f32_bf16 v82, v230, v38
    v_cvt_pk_bf16_f32 v77, v76, v78
    v_dot2c_f32_bf16 v83, v230, v42
    v_max3_f32 v92, v92, v76, v78
    v_dot2c_f32_bf16 v80, v227, v39
    v_lshlrev_b32 v76, 16, v77
    v_dot2c_f32_bf16 v81, v227, v43
    v_and_b32 v78, 0xffff0000, v77
    v_dot2c_f32_bf16 v82, v231, v39
    v_mul_f32 v76, 0x3db504f3, v76
    v_dot2c_f32_bf16 v83, v231, v43
    v_mul_f32 v78, 0x3db504f3, v78
    v_cvt_pk_bf16_f32 v58, v76, v78
    s_waitcnt vmcnt(6)
    s_cmpk_gt_u32 s42, 43
    s_cbranch_scc1 L_cu43
    s_waitcnt vmcnt(4)
L_cu43:
    s_mov_b32 s41, 405504
    buffer_load_dwordx4 v[132:135], v3, s[8:11], s41 offen nt
    v_dot2_f32_bf16 v76, v232, v36, 0
    v_dot2_f32_bf16 v77, v232, v40, 0
    v_dot2_f32_bf16 v78, v236, v36, 0
    v_add_f32_dpp v80, v81, v80 row_ror:8 row_mask:0xf bank_mask:0xf
    v_dot2_f32_bf16 v79, v236, v40, 0
    v_add_f32_dpp v82, v83, v82 row_ror:8 row_mask:0xf bank_mask:0xf
    v_dot2c_f32_bf16 v76, v233, v37
    v_add_f32_dpp v80, v80, v80 quad_perm:[1,0,3,2] row_mask:0xf bank_mask:0xf
    v_dot2c_f32_bf16 v77, v233, v41
    v_add_f32_dpp v82, v82, v82 quad_perm:[1,0,3,2] row_mask:0xf bank_mask:0xf
    v_dot2c_f32_bf16 v78, v237, v37
    v_add_f32_dpp v80, v80, v80 quad_perm:[2,3,0,1] row_mask:0xf bank_mask:0xf
    v_dot2c_f32_bf16 v79, v237, v41
    v_add_f32_dpp v82, v82, v82 quad_perm:[2,3,0,1] row_mask:0xf bank_mask:0xf
    v_dot2c_f32_bf16 v76, v234, v38
    v_add_f32_dpp v80, v80, v80 row_half_mirror row_mask:0xf bank_mask:0xf
    v_dot2c_f32_bf16 v77, v234, v42
    v_add_f32_dpp v82, v82, v82 row_half_mirror row_mask:0xf bank_mask:0xf
    v_dot2c_f32_bf16 v78, v238, v38
    v_cvt_pk_bf16_f32 v81, v80, v82
    v_dot2c_f32_bf16 v79, v238, v42
    v_max3_f32 v92, v92, v80, v82
    v_dot2c_f32_bf16 v76, v235, v39
    v_lshlrev_b32 v80, 16, v81
    v_dot2c_f32_bf16 v77, v235, v43
    v_and_b32 v82, 0xffff0000, v81
    v_dot2c_f32_bf16 v78, v239, v39
    v_mul_f32 v80, 0x3db504f3, v80
    v_dot2c_f32_bf16 v79, v239, v43
    v_mul_f32 v82, 0x3db504f3, v82
    v_cvt_pk_bf16_f32 v59, v80, v82
    s_waitcnt vmcnt(6)
    s_cmpk_gt_u32 s42, 44
    s_cbranch_scc1 L_cu44
    s_waitcnt vmcnt(4)
L_cu44:
    s_mov_b32 s41, 409600
    buffer_load_dwordx4 v[136:139], v3, s[8:11], s41 offen nt
    v_dot2_f32_bf16 v80, v240, v36, 0
    v_dot2_f32_bf16 v81, v240, v40, 0
    v_dot2_f32_bf16 v82, v244, v36, 0
    v_add_f32_dpp v76, v77, v76 row_ror:8 row_mask:0xf bank_mask:0xf
    v_dot2_f32_bf16 v83, v244, v40, 0
    v_add_f32_dpp v78, v79, v78 row_ror:8 row_mask:0xf bank_mask:0xf
    v_dot2c_f32_bf16 v80, v241, v37
    v_add_f32_dpp v76, v76, v76 quad_perm:[1,0,3,2] row_mask:0xf bank_mask:0xf
    v_dot2c_f32_bf16 v81, v241, v41
    v_add_f32_dpp v78, v78, v78 quad_perm:[1,0,3,2] row_mask:0xf bank_mask:0xf
    v_dot2c_f32_bf16 v82, v245, v37
    v_add_f32_dpp v76, v76, v76 quad_perm:[2,3,0,1] row_mask:0xf bank_mask:0xf
    v_dot2c_f32_bf16 v83, v245, v41
    v_add_f32_dpp v78, v78, v78 quad_perm:[2,3,0,1] row_mask:0xf bank_mask:0xf
    v_dot2c_f32_bf16 v80, v242, v38
    v_add_f32_dpp v76, v76, v76 row_half_mirror row_mask:0xf bank_mask:0xf
    v_dot2c_f32_bf16 v81, v242, v42
    v_add_f32_dpp v78, v78, v78 row_half_mirror row_mask:0xf bank_mask:0xf
    v_dot2c_f32_bf16 v82, v246, v38
    v_cvt_pk_bf16_f32 v77, v76, v78
    v_dot2c_f32_bf16 v83, v246, v42
    v_max3_f32 v92, v92, v76, v78
    v_dot2c_f32_bf16 v80, v243, v39
    v_lshlrev_b32 v76, 16, v77
    v_dot2c_f32_bf16 v81, v243, v43
    v_and_b32 v78, 0xffff0000, v77
    v_dot2c_f32_bf16 v82, v247, v39
    v_mul_f32 v76, 0x3db504f3, v76
    v_dot2c_f32_bf16 v83, v247, v43
    v_mul_f32 v78, 0x3db504f3, v78
    v_cvt_pk_bf16_f32 v60, v76, v78
    s_waitcnt vmcnt(6)
    s_cmpk_gt_u32 s42, 45
    s_cbranch_scc1 L_cu45
    s_waitcnt vmcnt(4)
L_cu45:
    s_mov_b32 s41, 413696
    buffer_load_dwordx4 v[140:143], v3, s[8:11], s41 offen nt
    v_dot2_f32_bf16 v76, v104, v36, 0
    v_dot2_f32_bf16 v77, v104, v40, 0
    v_dot2_f32_bf16 v78, v108, v36, 0
    v_add_f32_dpp v80, v81, v80 row_ror:8 row_mask:0xf bank_mask:0xf
    v_dot2_f32_bf16 v79, v108, v40, 0
    v_add_f32_dpp v82, v83, v82 row_ror:8 row_mask:0xf bank_mask:0xf
    v_dot2c_f32_bf16 v76, v105, v37
    v_add_f32_dpp v80, v80, v80 quad_perm:[1,0,3,2] row_mask:0xf bank_mask:0xf
    v_dot2c_f32_bf16 v77, v105, v41
    v_add_f32_dpp v82, v82, v82 quad_perm:[1,0,3,2] row_mask:0xf bank_mask:0xf
    v_dot2c_f32_bf16 v78, v109, v37
    v_add_f32_dpp v80, v80, v80 quad_perm:[2,3,0,1] row_mask:0xf bank_mask:0xf
    v_dot2c_f32_bf16 v79, v109, v41
    v_add_f32_dpp v82, v82, v82 quad_perm:[2,3,0,1] row_mask:0xf bank_mask:0xf
    v_dot2c_f32_bf16 v76, v106, v38
    v_add_f32_dpp v80, v80, v80 row_half_mirror row_mask:0xf bank_mask:0xf
    v_dot2c_f32_bf16 v77, v106, v42
    v_add_f32_dpp v82, v82, v82 row_half_mirror row_mask:0xf bank_mask:0xf
    v_dot2c_f32_bf16 v78, v110, v38
    v_cvt_pk_bf16_f32 v81, v80, v82
    v_dot2c_f32_bf16 v79, v110, v42
    v_max3_f32 v92, v92, v80, v82
    v_dot2c_f32_bf16 v76, v107, v39
    v_lshlrev_b32 v80, 16, v81
    v_dot2c_f32_bf16 v77, v107, v43
    v_and_b32 v82, 0xffff0000, v81
    v_dot2c_f32_bf16 v78, v111, v39
    v_mul_f32 v80, 0x3db504f3, v80
    v_dot2c_f32_bf16 v79, v111, v43
    v_mul_f32 v82, 0x3db504f3, v82
    v_cvt_pk_bf16_f32 v61, v80, v82
    s_waitcnt vmcnt(6)
    s_cmpk_gt_u32 s42, 46
    s_cbranch_scc1 L_cu46
    s_waitcnt vmcnt(4)
L_cu46:
    s_mov_b32 s41, 417792
    buffer_load_dwordx4 v[144:147], v3, s[8:11], s41 offen nt
    v_dot2_f32_bf16 v80, v112, v36, 0
    v_dot2_f32_bf16 v81, v112, v40, 0
    v_dot2_f32_bf16 v82, v116, v36, 0
    v_add_f32_dpp v76, v77, v76 row_ror:8 row_mask:0xf bank_mask:0xf
    v_dot2_f32_bf16 v83, v116, v40, 0
    v_add_f32_dpp v78, v79, v78 row_ror:8 row_mask:0xf bank_mask:0xf
    v_dot2c_f32_bf16 v80, v113, v37
    v_add_f32_dpp v76, v76, v76 quad_perm:[1,0,3,2] row_mask:0xf bank_mask:0xf
    v_dot2c_f32_bf16 v81, v113, v41
    v_add_f32_dpp v78, v78, v78 quad_perm:[1,0,3,2] row_mask:0xf bank_mask:0xf
    v_dot2c_f32_bf16 v82, v117, v37
    v_add_f32_dpp v76, v76, v76 quad_perm:[2,3,0,1] row_mask:0xf bank_mask:0xf
    v_dot2c_f32_bf16 v83, v117, v41
    v_add_f32_dpp v78, v78, v78 quad_perm:[2,3,0,1] row_mask:0xf bank_mask:0xf
    v_dot2c_f32_bf16 v80, v114, v38
    v_add_f32_dpp v76, v76, v76 row_half_mirror row_mask:0xf bank_mask:0xf
    v_dot2c_f32_bf16 v81, v114, v42
    v_add_f32_dpp v78, v78, v78 row_half_mirror row_mask:0xf bank_mask:0xf
    v_dot2c_f32_bf16 v82, v118, v38
    v_cvt_pk_bf16_f32 v77, v76, v78
    v_dot2c_f32_bf16 v83, v118, v42
    v_max3_f32 v92, v92, v76, v78
    v_dot2c_f32_bf16 v80, v115, v39
    v_lshlrev_b32 v76, 16, v77
    v_dot2c_f32_bf16 v81, v115, v43
    v_and_b32 v78, 0xffff0000, v77
    v_dot2c_f32_bf16 v82, v119, v39
    v_mul_f32 v76, 0x3db504f3, v76
    v_dot2c_f32_bf16 v83, v119, v43
    v_mul_f32 v78, 0x3db504f3, v78
    v_cvt_pk_bf16_f32 v62, v76, v78
    s_waitcnt vmcnt(6)
    s_cmpk_gt_u32 s42, 47
    s_cbranch_scc1 L_cu47
    s_waitcnt vmcnt(4)
L_cu47:
    s_mov_b32 s41, 421888
    buffer_load_dwordx4 v[148:151], v3, s[8:11], s41 offen nt
    s_waitcnt vmcnt(6)
    s_cmpk_gt_u32 s42, 48
    s_cbranch_scc1 L_cu48
    s_waitcnt vmcnt(4)
L_cu48:
    s_mov_b32 s41, 163840
    buffer_load_dwordx4 v[152:155], v3, s[8:11], s41 offen nt
    v_dot2_f32_bf16 v76, v120, v36, 0
    v_dot2_f32_bf16 v77, v120, v40, 0
    v_dot2_f32_bf16 v78, v124, v36, 0
    v_add_f32_dpp v80, v81, v80 row_ror:8 row_mask:0xf bank_mask:0xf
    v_dot2_f32_bf16 v79, v124, v40, 0
    v_add_f32_dpp v82, v83, v82 row_ror:8 row_mask:0xf bank_mask:0xf
    v_dot2c_f32_bf16 v76, v121, v37
    v_add_f32_dpp v80, v80, v80 quad_perm:[1,0,3,2] row_mask:0xf bank_mask:0xf
    v_dot2c_f32_bf16 v77, v121, v41
    v_add_f32_dpp v82, v82, v82 quad_perm:[1,0,3,2] row_mask:0xf bank_mask:0xf
    v_dot2c_f32_bf16 v78, v125, v37
    v_add_f32_dpp v80, v80, v80 quad_perm:[2,3,0,1] row_mask:0xf bank_mask:0xf
    v_dot2c_f32_bf16 v79, v125, v41
    v_add_f32_dpp v82, v82, v82 quad_perm:[2,3,0,1] row_mask:0xf bank_mask:0xf
    v_dot2c_f32_bf16 v76, v122, v38
    v_add_f32_dpp v80, v80, v80 row_half_mirror row_mask:0xf bank_mask:0xf
    v_dot2c_f32_bf16 v77, v122, v42
    v_add_f32_dpp v82, v82, v82 row_half_mirror row_mask:0xf bank_mask:0xf
    v_dot2c_f32_bf16 v78, v126, v38
    v_cvt_pk_bf16_f32 v81, v80, v82
    v_dot2c_f32_bf16 v79, v126, v42
    v_max3_f32 v92, v92, v80, v82
    v_dot2c_f32_bf16 v76, v123, v39
    v_lshlrev_b32 v80, 16, v81
    v_dot2c_f32_bf16 v77, v123, v43
    v_and_b32 v82, 0xffff0000, v81
    v_dot2c_f32_bf16 v78, v127, v39
    v_mul_f32 v80, 0x3db504f3, v80
    v_dot2c_f32_bf16 v79, v127, v43
    v_mul_f32 v82, 0x3db504f3, v82
    v_cvt_pk_bf16_f32 v63, v80, v82
    s_waitcnt vmcnt(6)
    s_cmpk_gt_u32 s42, 49
    s_cbranch_scc1 L_cu49
    s_waitcnt vmcnt(4)
L_cu49:
    s_mov_b32 s41, 167936
    buffer_load_dwordx4 v[156:159], v3, s[8:11], s41 offen nt
    s_waitcnt vmcnt(6)
    s_cmpk_gt_u32 s42, 50
    s_cbranch_scc1 L_cu50
    s_waitcnt vmcnt(4)
L_cu50:
    s_mov_b32 s41, 172032
    buffer_load_dwordx4 v[160:163], v3, s[8:11], s41 offen nt
    v_dot2_f32_bf16 v80, v128, v36, 0
    v_dot2_f32_bf16 v81, v128, v40, 0
    v_dot2_f32_bf16 v82, v132, v36, 0
    v_add_f32_dpp v76, v77, v76 row_ror:8 row_mask:0xf bank_mask:0xf
    v_dot2_f32_bf16 v83, v132, v40, 0
    v_add_f32_dpp v78, v79, v78 row_ror:8 row_mask:0xf bank_mask:0xf
    v_dot2c_f32_bf16 v80, v129, v37
    v_add_f32_dpp v76, v76, v76 quad_perm:[1,0,3,2] row_mask:0xf bank_mask:0xf
    v_dot2c_f32_bf16 v81, v129, v41
    v_add_f32_dpp v78, v78, v78 quad_perm:[1,0,3,2] row_mask:0xf bank_mask:0xf
    v_dot2c_f32_bf16 v82, v133, v37
    v_add_f32_dpp v76, v76, v76 quad_perm:[2,3,0,1] row_mask:0xf bank_mask:0xf
    v_dot2c_f32_bf16 v83, v133, v41
    v_add_f32_dpp v78, v78, v78 quad_perm:[2,3,0,1] row_mask:0xf bank_mask:0xf
    v_dot2c_f32_bf16 v80, v130, v38
    v_add_f32_dpp v76, v76, v76 row_half_mirror row_mask:0xf bank_mask:0xf
    v_dot2c_f32_bf16 v81, v130, v42
    v_add_f32_dpp v78, v78, v78 row_half_mirror row_mask:0xf bank_mask:0xf
    v_dot2c_f32_bf16 v82, v134, v38
    v_cvt_pk_bf16_f32 v77, v76, v78
    v_dot2c_f32_bf16 v83, v134, v42
    v_max3_f32 v92, v92, v76, v78
    v_dot2c_f32_bf16 v80, v131, v39
    v_lshlrev_b32 v76, 16, v77
    v_dot2c_f32_bf16 v81, v131, v43
    v_and_b32 v78, 0xffff0000, v77
    v_dot2c_f32_bf16 v82, v135, v39
    v_mul_f32 v76, 0x3db504f3, v76
    v_dot2c_f32_bf16 v83, v135, v43
    v_mul_f32 v78, 0x3db504f3, v78
    v_cvt_pk_bf16_f32 v64, v76, v78
    s_waitcnt vmcnt(6)
    s_cmpk_gt_u32 s42, 51
    s_cbranch_scc1 L_cu51
    s_waitcnt vmcnt(4)
L_cu51:
    s_mov_b32 s41, 176128
    buffer_load_dwordx4 v[164:167], v3, s[8:11], s41 offen nt
    s_waitcnt vmcnt(6)
    s_cmpk_gt_u32 s42, 52
    s_cbranch_scc1 L_cu52
    s_waitcnt vmcnt(4)
L_cu52:
    s_mov_b32 s41, 180224
    buffer_load_dwordx4 v[168:171], v3, s[8:11], s41 offen nt
    v_dot2_f32_bf16 v76, v136, v36, 0
    v_dot2_f32_bf16 v77, v136, v40, 0
    v_dot2_f32_bf16 v78, v140, v36, 0
    v_add_f32_dpp v80, v81, v80 row_ror:8 row_mask:0xf bank_mask:0xf
    v_dot2_f32_bf16 v79, v140, v40, 0
    v_add_f32_dpp v82, v83, v82 row_ror:8 row_mask:0xf bank_mask:0xf
    v_dot2c_f32_bf16 v76, v137, v37
    v_add_f32_dpp v80, v80, v80 quad_perm:[1,0,3,2] row_mask:0xf bank_mask:0xf
    v_dot2c_f32_bf16 v77, v137, v41
    v_add_f32_dpp v82, v82, v82 quad_perm:[1,0,3,2] row_mask:0xf bank_mask:0xf
    v_dot2c_f32_bf16 v78, v141, v37
    v_add_f32_dpp v80, v80, v80 quad_perm:[2,3,0,1] row_mask:0xf bank_mask:0xf
    v_dot2c_f32_bf16 v79, v141, v41
    v_add_f32_dpp v82, v82, v82 quad_perm:[2,3,0,1] row_mask:0xf bank_mask:0xf
    v_dot2c_f32_bf16 v76, v138, v38
    v_add_f32_dpp v80, v80, v80 row_half_mirror row_mask:0xf bank_mask:0xf
    v_dot2c_f32_bf16 v77, v138, v42
    v_add_f32_dpp v82, v82, v82 row_half_mirror row_mask:0xf bank_mask:0xf
    v_dot2c_f32_bf16 v78, v142, v38
    v_cvt_pk_bf16_f32 v81, v80, v82
    v_dot2c_f32_bf16 v79, v142, v42
    v_max3_f32 v92, v92, v80, v82
    v_dot2c_f32_bf16 v76, v139, v39
    v_lshlrev_b32 v80, 16, v81
    v_dot2c_f32_bf16 v77, v139, v43
    v_and_b32 v82, 0xffff0000, v81
    v_dot2c_f32_bf16 v78, v143, v39
    v_mul_f32 v80, 0x3db504f3, v80
    v_dot2c_f32_bf16 v79, v143, v43
    v_mul_f32 v82, 0x3db504f3, v82
    v_cvt_pk_bf16_f32 v65, v80, v82
    s_waitcnt vmcnt(6)
    s_cmpk_gt_u32 s42, 53
    s_cbranch_scc1 L_cu53
    s_waitcnt vmcnt(4)
L_cu53:
    s_mov_b32 s41, 184320
    buffer_load_dwordx4 v[172:175], v3, s[8:11], s41 offen nt
    s_waitcnt vmcnt(6)
    s_cmpk_gt_u32 s42, 54
    s_cbranch_scc1 L_cu54
    s_waitcnt vmcnt(4)
L_cu54:
    s_mov_b32 s41, 188416
    buffer_load_dwordx4 v[176:179], v3, s[8:11], s41 offen nt
    v_dot2_f32_bf16 v80, v144, v36, 0
    v_dot2_f32_bf16 v81, v144, v40, 0
    v_dot2_f32_bf16 v82, v148, v36, 0
    v_add_f32_dpp v76, v77, v76 row_ror:8 row_mask:0xf bank_mask:0xf
    v_dot2_f32_bf16 v83, v148, v40, 0
    v_add_f32_dpp v78, v79, v78 row_ror:8 row_mask:0xf bank_mask:0xf
    v_dot2c_f32_bf16 v80, v145, v37
    v_add_f32_dpp v76, v76, v76 quad_perm:[1,0,3,2] row_mask:0xf bank_mask:0xf
    v_dot2c_f32_bf16 v81, v145, v41
    v_add_f32_dpp v78, v78, v78 quad_perm:[1,0,3,2] row_mask:0xf bank_mask:0xf
    v_dot2c_f32_bf16 v82, v149, v37
    v_add_f32_dpp v76, v76, v76 quad_perm:[2,3,0,1] row_mask:0xf bank_mask:0xf
    v_dot2c_f32_bf16 v83, v149, v41
    v_add_f32_dpp v78, v78, v78 quad_perm:[2,3,0,1] row_mask:0xf bank_mask:0xf
    v_dot2c_f32_bf16 v80, v146, v38
    v_add_f32_dpp v76, v76, v76 row_half_mirror row_mask:0xf bank_mask:0xf
    v_dot2c_f32_bf16 v81, v146, v42
    v_add_f32_dpp v78, v78, v78 row_half_mirror row_mask:0xf bank_mask:0xf
    v_dot2c_f32_bf16 v82, v150, v38
    v_cvt_pk_bf16_f32 v77, v76, v78
    v_dot2c_f32_bf16 v83, v150, v42
    v_max3_f32 v92, v92, v76, v78
    v_dot2c_f32_bf16 v80, v147, v39
    v_lshlrev_b32 v76, 16, v77
    v_dot2c_f32_bf16 v81, v147, v43
    v_and_b32 v78, 0xffff0000, v77
    v_dot2c_f32_bf16 v82, v151, v39
    v_mul_f32 v76, 0x3db504f3, v76
    v_dot2c_f32_bf16 v83, v151, v43
    v_mul_f32 v78, 0x3db504f3, v78
    v_cvt_pk_bf16_f32 v66, v76, v78
    s_waitcnt vmcnt(6)
    s_cmpk_gt_u32 s42, 55
    s_cbranch_scc1 L_cu55
    s_waitcnt vmcnt(4)
L_cu55:
    s_mov_b32 s41, 192512
    buffer_load_dwordx4 v[180:183], v3, s[8:11], s41 offen nt
    s_waitcnt vmcnt(6)
    s_cmpk_gt_u32 s42, 56
    s_cbranch_scc1 L_cu56
    s_waitcnt vmcnt(4)
L_cu56:
    s_mov_b32 s41, 425984
    buffer_load_dwordx4 v[184:187], v3, s[8:11], s41 offen nt
    v_dot2_f32_bf16 v76, v152, v36, 0
    v_dot2_f32_bf16 v77, v152, v40, 0
    v_dot2_f32_bf16 v78, v156, v36, 0
    v_add_f32_dpp v80, v81, v80 row_ror:8 row_mask:0xf bank_mask:0xf
    v_dot2_f32_bf16 v79, v156, v40, 0
    v_add_f32_dpp v82, v83, v82 row_ror:8 row_mask:0xf bank_mask:0xf
    v_dot2c_f32_bf16 v76, v153, v37
    v_add_f32_dpp v80, v80, v80 quad_perm:[1,0,3,2] row_mask:0xf bank_mask:0xf
    v_dot2c_f32_bf16 v77, v153, v41
    v_add_f32_dpp v82, v82, v82 quad_perm:[1,0,3,2] row_mask:0xf bank_mask:0xf
    v_dot2c_f32_bf16 v78, v157, v37
    v_add_f32_dpp v80, v80, v80 quad_perm:[2,3,0,1] row_mask:0xf bank_mask:0xf
    v_dot2c_f32_bf16 v79, v157, v41
    v_add_f32_dpp v82, v82, v82 quad_perm:[2,3,0,1] row_mask:0xf bank_mask:0xf
    v_dot2c_f32_bf16 v76, v154, v38
    v_add_f32_dpp v80, v80, v80 row_half_mirror row_mask:0xf bank_mask:0xf
    v_dot2c_f32_bf16 v77, v154, v42
    v_add_f32_dpp v82, v82, v82 row_half_mirror row_mask:0xf bank_mask:0xf
    v_dot2c_f32_bf16 v78, v158, v38
    v_cvt_pk_bf16_f32 v81, v80, v82
    v_dot2c_f32_bf16 v79, v158, v42
    v_max3_f32 v92, v92, v80, v82
    v_dot2c_f32_bf16 v76, v155, v39
    v_lshlrev_b32 v80, 16, v81
    v_dot2c_f32_bf16 v77, v155, v43
    v_and_b32 v82, 0xffff0000, v81
    v_dot2c_f32_bf16 v78, v159, v39
    v_mul_f32 v80, 0x3db504f3, v80
    v_dot2c_f32_bf16 v79, v159, v43
    v_mul_f32 v82, 0x3db504f3, v82
    v_cvt_pk_bf16_f32 v67, v80, v82
    s_waitcnt vmcnt(6)
    s_cmpk_gt_u32 s42, 57
    s_cbranch_scc1 L_cu57
    s_waitcnt vmcnt(4)
L_cu57:
    s_mov_b32 s41, 430080
    buffer_load_dwordx4 v[188:191], v3, s[8:11], s41 offen nt
    s_waitcnt vmcnt(6)
    s_cmpk_gt_u32 s42, 58
    s_cbranch_scc1 L_cu58
    s_waitcnt vmcnt(5)
L_cu58:
    s_mov_b32 s41, 434176
    buffer_load_dwordx4 v[192:195], v3, s[8:11], s41 offen nt
    v_dot2_f32_bf16 v80, v160, v36, 0
    v_dot2_f32_bf16 v81, v160, v40, 0
    v_dot2_f32_bf16 v82, v164, v36, 0
    v_add_f32_dpp v76, v77, v76 row_ror:8 row_mask:0xf bank_mask:0xf
    v_dot2_f32_bf16 v83, v164, v40, 0
    v_add_f32_dpp v78, v79, v78 row_ror:8 row_mask:0xf bank_mask:0xf
    v_dot2c_f32_bf16 v80, v161, v37
    v_add_f32_dpp v76, v76, v76 quad_perm:[1,0,3,2] row_mask:0xf bank_mask:0xf
    v_dot2c_f32_bf16 v81, v161, v41
    v_add_f32_dpp v78, v78, v78 quad_perm:[1,0,3,2] row_mask:0xf bank_mask:0xf
    v_dot2c_f32_bf16 v82, v165, v37
    v_add_f32_dpp v76, v76, v76 quad_perm:[2,3,0,1] row_mask:0xf bank_mask:0xf
    v_dot2c_f32_bf16 v83, v165, v41
    v_add_f32_dpp v78, v78, v78 quad_perm:[2,3,0,1] row_mask:0xf bank_mask:0xf
    v_dot2c_f32_bf16 v80, v162, v38
    v_add_f32_dpp v76, v76, v76 row_half_mirror row_mask:0xf bank_mask:0xf
    v_dot2c_f32_bf16 v81, v162, v42
    v_add_f32_dpp v78, v78, v78 row_half_mirror row_mask:0xf bank_mask:0xf
    v_dot2c_f32_bf16 v82, v166, v38
    v_cvt_pk_bf16_f32 v77, v76, v78
    v_dot2c_f32_bf16 v83, v166, v42
    v_max3_f32 v92, v92, v76, v78
    v_dot2c_f32_bf16 v80, v163, v39
    v_lshlrev_b32 v76, 16, v77
    v_dot2c_f32_bf16 v81, v163, v43
    v_and_b32 v78, 0xffff0000, v77
    v_dot2c_f32_bf16 v82, v167, v39
    v_mul_f32 v76, 0x3db504f3, v76
    v_dot2c_f32_bf16 v83, v167, v43
    v_mul_f32 v78, 0x3db504f3, v78
    v_cvt_pk_bf16_f32 v68, v76, v78
    s_waitcnt vmcnt(6)
    s_cmpk_gt_u32 s42, 59
    s_cbranch_scc1 L_cu59
    s_waitcnt vmcnt(5)
L_cu59:
    s_mov_b32 s41, 438272
    buffer_load_dwordx4 v[196:199], v3, s[8:11], s41 offen nt
    s_waitcnt vmcnt(6)
    s_cmpk_gt_u32 s42, 60
    s_cbranch_scc1 L_cu60
    s_waitcnt vmcnt(5)
L_cu60:
    s_mov_b32 s41, 442368
    buffer_load_dwordx4 v[200:203], v3, s[8:11], s41 offen nt
    v_dot2_f32_bf16 v76, v168, v36, 0
    v_dot2_f32_bf16 v77, v168, v40, 0
    v_dot2_f32_bf16 v78, v172, v36, 0
    v_add_f32_dpp v80, v81, v80 row_ror:8 row_mask:0xf bank_mask:0xf
    v_dot2_f32_bf16 v79, v172, v40, 0
    v_add_f32_dpp v82, v83, v82 row_ror:8 row_mask:0xf bank_mask:0xf
    v_dot2c_f32_bf16 v76, v169, v37
    v_add_f32_dpp v80, v80, v80 quad_perm:[1,0,3,2] row_mask:0xf bank_mask:0xf
    v_dot2c_f32_bf16 v77, v169, v41
    v_add_f32_dpp v82, v82, v82 quad_perm:[1,0,3,2] row_mask:0xf bank_mask:0xf
    v_dot2c_f32_bf16 v78, v173, v37
    v_add_f32_dpp v80, v80, v80 quad_perm:[2,3,0,1] row_mask:0xf bank_mask:0xf
    v_dot2c_f32_bf16 v79, v173, v41
    v_add_f32_dpp v82, v82, v82 quad_perm:[2,3,0,1] row_mask:0xf bank_mask:0xf
    v_dot2c_f32_bf16 v76, v170, v38
    v_add_f32_dpp v80, v80, v80 row_half_mirror row_mask:0xf bank_mask:0xf
    v_dot2c_f32_bf16 v77, v170, v42
    v_add_f32_dpp v82, v82, v82 row_half_mirror row_mask:0xf bank_mask:0xf
    v_dot2c_f32_bf16 v78, v174, v38
    v_cvt_pk_bf16_f32 v81, v80, v82
    v_dot2c_f32_bf16 v79, v174, v42
    v_max3_f32 v92, v92, v80, v82
    v_dot2c_f32_bf16 v76, v171, v39
    v_lshlrev_b32 v80, 16, v81
    v_dot2c_f32_bf16 v77, v171, v43
    v_and_b32 v82, 0xffff0000, v81
    v_dot2c_f32_bf16 v78, v175, v39
    v_mul_f32 v80, 0x3db504f3, v80
    v_dot2c_f32_bf16 v79, v175, v43
    v_mul_f32 v82, 0x3db504f3, v82
    v_cvt_pk_bf16_f32 v69, v80, v82
    s_waitcnt vmcnt(6)
    s_cmpk_gt_u32 s42, 61
    s_cbranch_scc1 L_cu61
    s_waitcnt vmcnt(5)
L_cu61:
    s_mov_b32 s41, 446464
    buffer_load_dwordx4 v[204:207], v3, s[8:11], s41 offen nt
    s_waitcnt vmcnt(6)
    s_cmpk_gt_u32 s42, 62
    s_cbranch_scc1 L_cu62
    s_waitcnt vmcnt(5)
L_cu62:
    s_mov_b32 s41, 450560
    buffer_load_dwordx4 v[208:211], v3, s[8:11], s41 offen nt
    v_dot2_f32_bf16 v80, v176, v36, 0
    v_dot2_f32_bf16 v81, v176, v40, 0
    v_dot2_f32_bf16 v82, v180, v36, 0
    v_add_f32_dpp v76, v77, v76 row_ror:8 row_mask:0xf bank_mask:0xf
    v_dot2_f32_bf16 v83, v180, v40, 0
    v_add_f32_dpp v78, v79, v78 row_ror:8 row_mask:0xf bank_mask:0xf
    v_dot2c_f32_bf16 v80, v177, v37
    v_add_f32_dpp v76, v76, v76 quad_perm:[1,0,3,2] row_mask:0xf bank_mask:0xf
    v_dot2c_f32_bf16 v81, v177, v41
    v_add_f32_dpp v78, v78, v78 quad_perm:[1,0,3,2] row_mask:0xf bank_mask:0xf
    v_dot2c_f32_bf16 v82, v181, v37
    v_add_f32_dpp v76, v76, v76 quad_perm:[2,3,0,1] row_mask:0xf bank_mask:0xf
    v_dot2c_f32_bf16 v83, v181, v41
    v_add_f32_dpp v78, v78, v78 quad_perm:[2,3,0,1] row_mask:0xf bank_mask:0xf
    v_dot2c_f32_bf16 v80, v178, v38
    v_add_f32_dpp v76, v76, v76 row_half_mirror row_mask:0xf bank_mask:0xf
    v_dot2c_f32_bf16 v81, v178, v42
    v_add_f32_dpp v78, v78, v78 row_half_mirror row_mask:0xf bank_mask:0xf
    v_dot2c_f32_bf16 v82, v182, v38
    v_cvt_pk_bf16_f32 v77, v76, v78
    v_dot2c_f32_bf16 v83, v182, v42
    v_max3_f32 v92, v92, v76, v78
    v_dot2c_f32_bf16 v80, v179, v39
    v_lshlrev_b32 v76, 16, v77
    v_dot2c_f32_bf16 v81, v179, v43
    v_and_b32 v78, 0xffff0000, v77
    v_dot2c_f32_bf16 v82, v183, v39
    v_mul_f32 v76, 0x3db504f3, v76
    v_dot2c_f32_bf16 v83, v183, v43
    v_mul_f32 v78, 0x3db504f3, v78
    v_cvt_pk_bf16_f32 v70, v76, v78
    s_waitcnt vmcnt(6)
    s_cmpk_gt_u32 s42, 63
    s_cbranch_scc1 L_cu63
    s_waitcnt vmcnt(5)
L_cu63:
    s_mov_b32 s41, 454656
    buffer_load_dwordx4 v[212:215], v3, s[8:11], s41 offen nt
    s_waitcnt vmcnt(6)
    v_xor_b32 v3, 0x200000, v3
    s_cmpk_gt_u32 s42, 64
    s_cbranch_scc1 L_cu64
    s_waitcnt vmcnt(5)
L_cu64:
    buffer_load_dwordx4 v[216:219], v3, s[12:15], 0 offen nt
    v_dot2_f32_bf16 v76, v184, v36, 0
    v_dot2_f32_bf16 v77, v184, v40, 0
    v_dot2_f32_bf16 v78, v188, v36, 0
    v_add_f32_dpp v80, v81, v80 row_ror:8 row_mask:0xf bank_mask:0xf
    v_dot2_f32_bf16 v79, v188, v40, 0
    v_add_f32_dpp v82, v83, v82 row_ror:8 row_mask:0xf bank_mask:0xf
    v_dot2c_f32_bf16 v76, v185, v37
    v_add_f32_dpp v80, v80, v80 quad_perm:[1,0,3,2] row_mask:0xf bank_mask:0xf
    v_dot2c_f32_bf16 v77, v185, v41
    v_add_f32_dpp v82, v82, v82 quad_perm:[1,0,3,2] row_mask:0xf bank_mask:0xf
    v_dot2c_f32_bf16 v78, v189, v37
    v_add_f32_dpp v80, v80, v80 quad_perm:[2,3,0,1] row_mask:0xf bank_mask:0xf
    v_dot2c_f32_bf16 v79, v189, v41
    v_add_f32_dpp v82, v82, v82 quad_perm:[2,3,0,1] row_mask:0xf bank_mask:0xf
    v_dot2c_f32_bf16 v76, v186, v38
    v_add_f32_dpp v80, v80, v80 row_half_mirror row_mask:0xf bank_mask:0xf
    v_dot2c_f32_bf16 v77, v186, v42
    v_add_f32_dpp v82, v82, v82 row_half_mirror row_mask:0xf bank_mask:0xf
    v_dot2c_f32_bf16 v78, v190, v38
    v_cvt_pk_bf16_f32 v81, v80, v82
    v_dot2c_f32_bf16 v79, v190, v42
    v_max3_f32 v92, v92, v80, v82
    v_dot2c_f32_bf16 v76, v187, v39
    v_lshlrev_b32 v80, 16, v81
    v_dot2c_f32_bf16 v77, v187, v43
    v_and_b32 v82, 0xffff0000, v81
    v_dot2c_f32_bf16 v78, v191, v39
    v_mul_f32 v80, 0x3db504f3, v80
    v_dot2c_f32_bf16 v79, v191, v43
    v_mul_f32 v82, 0x3db504f3, v82
    v_cvt_pk_bf16_f32 v71, v80, v82
    s_waitcnt vmcnt(6)
    s_cmpk_gt_u32 s42, 65
    s_cbranch_scc1 L_cu65
    s_waitcnt vmcnt(5)
L_cu65:
    s_movk_i32 s41, 4096
    buffer_load_dwordx4 v[220:223], v3, s[12:15], s41 offen nt
    s_waitcnt vmcnt(6)
    s_cmpk_gt_u32 s42, 66
    s_cbranch_scc1 L_cu66
    s_waitcnt vmcnt(5)
L_cu66:
    s_movk_i32 s41, 8192
    buffer_load_dwordx4 v[224:227], v3, s[12:15], s41 offen nt
    v_dot2_f32_bf16 v80, v192, v36, 0
    v_dot2_f32_bf16 v81, v192, v40, 0
    v_dot2_f32_bf16 v82, v196, v36, 0
    v_add_f32_dpp v76, v77, v76 row_ror:8 row_mask:0xf bank_mask:0xf
    v_dot2_f32_bf16 v83, v196, v40, 0
    v_add_f32_dpp v78, v79, v78 row_ror:8 row_mask:0xf bank_mask:0xf
    v_dot2c_f32_bf16 v80, v193, v37
    v_add_f32_dpp v76, v76, v76 quad_perm:[1,0,3,2] row_mask:0xf bank_mask:0xf
    v_dot2c_f32_bf16 v81, v193, v41
    v_add_f32_dpp v78, v78, v78 quad_perm:[1,0,3,2] row_mask:0xf bank_mask:0xf
    v_dot2c_f32_bf16 v82, v197, v37
    v_add_f32_dpp v76, v76, v76 quad_perm:[2,3,0,1] row_mask:0xf bank_mask:0xf
    v_dot2c_f32_bf16 v83, v197, v41
    v_add_f32_dpp v78, v78, v78 quad_perm:[2,3,0,1] row_mask:0xf bank_mask:0xf
    v_dot2c_f32_bf16 v80, v194, v38
    v_add_f32_dpp v76, v76, v76 row_half_mirror row_mask:0xf bank_mask:0xf
    v_dot2c_f32_bf16 v81, v194, v42
    v_add_f32_dpp v78, v78, v78 row_half_mirror row_mask:0xf bank_mask:0xf
    v_dot2c_f32_bf16 v82, v198, v38
    v_cvt_pk_bf16_f32 v77, v76, v78
    v_dot2c_f32_bf16 v83, v198, v42
    v_max3_f32 v92, v92, v76, v78
    v_dot2c_f32_bf16 v80, v195, v39
    v_lshlrev_b32 v76, 16, v77
    v_dot2c_f32_bf16 v81, v195, v43
    v_and_b32 v78, 0xffff0000, v77
    v_dot2c_f32_bf16 v82, v199, v39
    v_mul_f32 v76, 0x3db504f3, v76
    v_dot2c_f32_bf16 v83, v199, v43
    v_mul_f32 v78, 0x3db504f3, v78
    v_cvt_pk_bf16_f32 v72, v76, v78
    s_waitcnt vmcnt(6)
    s_cmpk_gt_u32 s42, 67
    s_cbranch_scc1 L_cu67
    s_waitcnt vmcnt(5)
L_cu67:
    s_movk_i32 s41, 12288
    buffer_load_dwordx4 v[228:231], v3, s[12:15], s41 offen nt
    s_waitcnt vmcnt(6)
    s_cmpk_gt_u32 s42, 68
    s_cbranch_scc1 L_cu68
    s_waitcnt vmcnt(5)
L_cu68:
    s_movk_i32 s41, 16384
    buffer_load_dwordx4 v[232:235], v3, s[12:15], s41 offen nt
    v_dot2_f32_bf16 v76, v200, v36, 0
    v_dot2_f32_bf16 v77, v200, v40, 0
    v_dot2_f32_bf16 v78, v204, v36, 0
    v_add_f32_dpp v80, v81, v80 row_ror:8 row_mask:0xf bank_mask:0xf
    v_dot2_f32_bf16 v79, v204, v40, 0
    v_add_f32_dpp v82, v83, v82 row_ror:8 row_mask:0xf bank_mask:0xf
    v_dot2c_f32_bf16 v76, v201, v37
    v_add_f32_dpp v80, v80, v80 quad_perm:[1,0,3,2] row_mask:0xf bank_mask:0xf
    v_dot2c_f32_bf16 v77, v201, v41
    v_add_f32_dpp v82, v82, v82 quad_perm:[1,0,3,2] row_mask:0xf bank_mask:0xf
    v_dot2c_f32_bf16 v78, v205, v37
    v_add_f32_dpp v80, v80, v80 quad_perm:[2,3,0,1] row_mask:0xf bank_mask:0xf
    v_dot2c_f32_bf16 v79, v205, v41
    v_add_f32_dpp v82, v82, v82 quad_perm:[2,3,0,1] row_mask:0xf bank_mask:0xf
    v_dot2c_f32_bf16 v76, v202, v38
    v_add_f32_dpp v80, v80, v80 row_half_mirror row_mask:0xf bank_mask:0xf
    v_dot2c_f32_bf16 v77, v202, v42
    v_add_f32_dpp v82, v82, v82 row_half_mirror row_mask:0xf bank_mask:0xf
    v_dot2c_f32_bf16 v78, v206, v38
    v_cvt_pk_bf16_f32 v81, v80, v82
    v_dot2c_f32_bf16 v79, v206, v42
    v_max3_f32 v92, v92, v80, v82
    v_dot2c_f32_bf16 v76, v203, v39
    v_lshlrev_b32 v80, 16, v81
    v_dot2c_f32_bf16 v77, v203, v43
    v_and_b32 v82, 0xffff0000, v81
    v_dot2c_f32_bf16 v78, v207, v39
    v_mul_f32 v80, 0x3db504f3, v80
    v_dot2c_f32_bf16 v79, v207, v43
    v_mul_f32 v82, 0x3db504f3, v82
    v_cvt_pk_bf16_f32 v73, v80, v82
    s_waitcnt vmcnt(6)
    s_cmpk_gt_u32 s42, 69
    s_cbranch_scc1 L_cu69
    s_waitcnt vmcnt(5)
L_cu69:
    s_movk_i32 s41, 20480
    buffer_load_dwordx4 v[236:239], v3, s[12:15], s41 offen nt
    s_waitcnt vmcnt(6)
    s_cmpk_gt_u32 s42, 70
    s_cbranch_scc1 L_cu70
    s_waitcnt vmcnt(5)
L_cu70:
    s_movk_i32 s41, 24576
    buffer_load_dwordx4 v[240:243], v3, s[12:15], s41 offen nt
    v_dot2_f32_bf16 v80, v208, v36, 0
    v_dot2_f32_bf16 v81, v208, v40, 0
    v_dot2_f32_bf16 v82, v212, v36, 0
    v_add_f32_dpp v76, v77, v76 row_ror:8 row_mask:0xf bank_mask:0xf
    v_dot2_f32_bf16 v83, v212, v40, 0
    v_add_f32_dpp v78, v79, v78 row_ror:8 row_mask:0xf bank_mask:0xf
    v_dot2c_f32_bf16 v80, v209, v37
    v_add_f32_dpp v76, v76, v76 quad_perm:[1,0,3,2] row_mask:0xf bank_mask:0xf
    v_dot2c_f32_bf16 v81, v209, v41
    v_add_f32_dpp v78, v78, v78 quad_perm:[1,0,3,2] row_mask:0xf bank_mask:0xf
    v_dot2c_f32_bf16 v82, v213, v37
    v_add_f32_dpp v76, v76, v76 quad_perm:[2,3,0,1] row_mask:0xf bank_mask:0xf
    v_dot2c_f32_bf16 v83, v213, v41
    v_add_f32_dpp v78, v78, v78 quad_perm:[2,3,0,1] row_mask:0xf bank_mask:0xf
    v_dot2c_f32_bf16 v80, v210, v38
    v_add_f32_dpp v76, v76, v76 row_half_mirror row_mask:0xf bank_mask:0xf
    v_dot2c_f32_bf16 v81, v210, v42
    v_add_f32_dpp v78, v78, v78 row_half_mirror row_mask:0xf bank_mask:0xf
    v_dot2c_f32_bf16 v82, v214, v38
    v_cvt_pk_bf16_f32 v77, v76, v78
    v_dot2c_f32_bf16 v83, v214, v42
    v_max3_f32 v92, v92, v76, v78
    v_dot2c_f32_bf16 v80, v211, v39
    v_lshlrev_b32 v76, 16, v77
    v_dot2c_f32_bf16 v81, v211, v43
    v_and_b32 v78, 0xffff0000, v77
    v_dot2c_f32_bf16 v82, v215, v39
    v_mul_f32 v76, 0x3db504f3, v76
    v_dot2c_f32_bf16 v83, v215, v43
    v_mul_f32 v78, 0x3db504f3, v78
    v_cvt_pk_bf16_f32 v74, v76, v78
    s_waitcnt vmcnt(6)
    s_cmpk_gt_u32 s42, 71
    s_cbranch_scc1 L_cu71
    s_waitcnt vmcnt(5)
L_cu71:
    s_movk_i32 s41, 28672
    buffer_load_dwordx4 v[244:247], v3, s[12:15], s41 offen nt
    v_add_f32_dpp v80, v81, v80 row_ror:8 row_mask:0xf bank_mask:0xf
    v_add_f32_dpp v82, v83, v82 row_ror:8 row_mask:0xf bank_mask:0xf
    s_nop 0
    v_add_f32_dpp v80, v80, v80 quad_perm:[1,0,3,2] row_mask:0xf bank_mask:0xf
    v_add_f32_dpp v82, v82, v82 quad_perm:[1,0,3,2] row_mask:0xf bank_mask:0xf
    s_nop 0
    v_add_f32_dpp v80, v80, v80 quad_perm:[2,3,0,1] row_mask:0xf bank_mask:0xf
    v_add_f32_dpp v82, v82, v82 quad_perm:[2,3,0,1] row_mask:0xf bank_mask:0xf
    s_nop 0
    v_add_f32_dpp v80, v80, v80 row_half_mirror row_mask:0xf bank_mask:0xf
    v_add_f32_dpp v82, v82, v82 row_half_mirror row_mask:0xf bank_mask:0xf
    v_cvt_pk_bf16_f32 v81, v80, v82
    v_max3_f32 v92, v92, v80, v82
    v_lshlrev_b32 v80, 16, v81
    v_and_b32 v82, 0xffff0000, v81
    v_mul_f32 v80, 0x3db504f3, v80
    v_mul_f32 v82, 0x3db504f3, v82
    v_cvt_pk_bf16_f32 v75, v80, v82
    v_mov_b32 v84, v92
    s_nop 1
    v_permlane16_swap_b32 v92, v84
    v_max_f32 v92, v92, v84
    v_mov_b32 v84, v92
    s_nop 1
    v_permlane32_swap_b32 v92, v84
    v_max_f32 v92, v92, v84
    v_cvt_pk_bf16_f32 v92, v92, v92
    v_and_b32 v92, 0xffff0000, v92
    v_mul_f32 v92, 0x3db504f3, v92
    v_cvt_pk_bf16_f32 v92, v92, v92
    v_and_b32 v92, 0xffff0000, v92
    v_mov_b32 v93, 0
    v_mov_b32 v87, 0
    s_waitcnt vmcnt(6)
    s_cmpk_gt_u32 s42, 72
    s_cbranch_scc1 L_cu72
    s_waitcnt vmcnt(5)
L_cu72:
    s_mov_b32 s41, 262144
    buffer_load_dwordx4 v[104:107], v3, s[12:15], s41 offen nt
    v_lshlrev_b32 v76, 16, v44
    v_lshlrev_b32 v78, 16, v45
    v_and_b32 v77, 0xffff0000, v44
    v_and_b32 v79, 0xffff0000, v45
    v_sub_f32 v76, v76, v92
    v_sub_f32 v78, v78, v92
    v_sub_f32 v77, v77, v92
    v_sub_f32 v79, v79, v92
    v_mul_f32 v76, 0x3fb8aa3b, v76
    v_mul_f32 v78, 0x3fb8aa3b, v78
    v_mul_f32 v77, 0x3fb8aa3b, v77
    v_mul_f32 v79, 0x3fb8aa3b, v79
    v_exp_f32 v76, v76
    v_exp_f32 v78, v78
    v_exp_f32 v77, v77
    v_exp_f32 v79, v79
    v_add_f32 v93, v93, v76
    v_add_f32 v93, v93, v78
    v_add_f32 v87, v87, v77
    v_add_f32 v87, v87, v79
    v_cvt_pk_bf16_f32 v44, v76, v77
    v_cvt_pk_bf16_f32 v45, v78, v79
    v_lshlrev_b32 v76, 16, v46
    v_lshlrev_b32 v78, 16, v47
    v_and_b32 v77, 0xffff0000, v46
    v_and_b32 v79, 0xffff0000, v47
    v_sub_f32 v76, v76, v92
    v_sub_f32 v78, v78, v92
    v_sub_f32 v77, v77, v92
    v_sub_f32 v79, v79, v92
    v_mul_f32 v76, 0x3fb8aa3b, v76
    v_mul_f32 v78, 0x3fb8aa3b, v78
    v_mul_f32 v77, 0x3fb8aa3b, v77
    v_mul_f32 v79, 0x3fb8aa3b, v79
    v_exp_f32 v76, v76
    v_exp_f32 v78, v78
    v_exp_f32 v77, v77
    v_exp_f32 v79, v79
    v_add_f32 v93, v93, v76
    v_add_f32 v93, v93, v78
    v_add_f32 v87, v87, v77
    v_add_f32 v87, v87, v79
    v_cvt_pk_bf16_f32 v46, v76, v77
    v_cvt_pk_bf16_f32 v47, v78, v79
    s_waitcnt vmcnt(6)
    s_cmpk_gt_u32 s42, 73
    s_cbranch_scc1 L_cu73
    s_waitcnt vmcnt(5)
L_cu73:
    s_mov_b32 s41, 266240
    buffer_load_dwordx4 v[108:111], v3, s[12:15], s41 offen nt
    v_lshlrev_b32 v76, 16, v48
    v_lshlrev_b32 v78, 16, v49
    v_and_b32 v77, 0xffff0000, v48
    v_and_b32 v79, 0xffff0000, v49
    v_sub_f32 v76, v76, v92
    v_sub_f32 v78, v78, v92
    v_sub_f32 v77, v77, v92
    v_sub_f32 v79, v79, v92
    v_mul_f32 v76, 0x3fb8aa3b, v76
    v_mul_f32 v78, 0x3fb8aa3b, v78
    v_mul_f32 v77, 0x3fb8aa3b, v77
    v_mul_f32 v79, 0x3fb8aa3b, v79
    v_exp_f32 v76, v76
    v_exp_f32 v78, v78
    v_exp_f32 v77, v77
    v_exp_f32 v79, v79
    v_add_f32 v93, v93, v76
    v_add_f32 v93, v93, v78
    v_add_f32 v87, v87, v77
    v_add_f32 v87, v87, v79
    v_cvt_pk_bf16_f32 v48, v76, v77
    v_cvt_pk_bf16_f32 v49, v78, v79
    v_lshlrev_b32 v76, 16, v50
    v_lshlrev_b32 v78, 16, v51
    v_and_b32 v77, 0xffff0000, v50
    v_and_b32 v79, 0xffff0000, v51
    v_sub_f32 v76, v76, v92
    v_sub_f32 v78, v78, v92
    v_sub_f32 v77, v77, v92
    v_sub_f32 v79, v79, v92
    v_mul_f32 v76, 0x3fb8aa3b, v76
    v_mul_f32 v78, 0x3fb8aa3b, v78
    v_mul_f32 v77, 0x3fb8aa3b, v77
    v_mul_f32 v79, 0x3fb8aa3b, v79
    v_exp_f32 v76, v76
    v_exp_f32 v78, v78
    v_exp_f32 v77, v77
    v_exp_f32 v79, v79
    v_add_f32 v93, v93, v76
    v_add_f32 v93, v93, v78
    v_add_f32 v87, v87, v77
    v_add_f32 v87, v87, v79
    v_cvt_pk_bf16_f32 v50, v76, v77
    v_cvt_pk_bf16_f32 v51, v78, v79
    s_waitcnt vmcnt(6)
    s_cmpk_gt_u32 s42, 74
    s_cbranch_scc1 L_cu74
    s_waitcnt vmcnt(5)
L_cu74:
    s_mov_b32 s41, 270336
    buffer_load_dwordx4 v[112:115], v3, s[12:15], s41 offen nt
    v_lshlrev_b32 v76, 16, v52
    v_lshlrev_b32 v78, 16, v53
    v_and_b32 v77, 0xffff0000, v52
    v_and_b32 v79, 0xffff0000, v53
    v_sub_f32 v76, v76, v92
    v_sub_f32 v78, v78, v92
    v_sub_f32 v77, v77, v92
    v_sub_f32 v79, v79, v92
    v_mul_f32 v76, 0x3fb8aa3b, v76
    v_mul_f32 v78, 0x3fb8aa3b, v78
    v_mul_f32 v77, 0x3fb8aa3b, v77
    v_mul_f32 v79, 0x3fb8aa3b, v79
    v_exp_f32 v76, v76
    v_exp_f32 v78, v78
    v_exp_f32 v77, v77
    v_exp_f32 v79, v79
    v_add_f32 v93, v93, v76
    v_add_f32 v93, v93, v78
    v_add_f32 v87, v87, v77
    v_add_f32 v87, v87, v79
    v_cvt_pk_bf16_f32 v52, v76, v77
    v_cvt_pk_bf16_f32 v53, v78, v79
    v_lshlrev_b32 v76, 16, v54
    v_lshlrev_b32 v78, 16, v55
    v_and_b32 v77, 0xffff0000, v54
    v_and_b32 v79, 0xffff0000, v55
    v_sub_f32 v76, v76, v92
    v_sub_f32 v78, v78, v92
    v_sub_f32 v77, v77, v92
    v_sub_f32 v79, v79, v92
    v_mul_f32 v76, 0x3fb8aa3b, v76
    v_mul_f32 v78, 0x3fb8aa3b, v78
    v_mul_f32 v77, 0x3fb8aa3b, v77
    v_mul_f32 v79, 0x3fb8aa3b, v79
    v_exp_f32 v76, v76
    v_exp_f32 v78, v78
    v_exp_f32 v77, v77
    v_exp_f32 v79, v79
    v_add_f32 v93, v93, v76
    v_add_f32 v93, v93, v78
    v_add_f32 v87, v87, v77
    v_add_f32 v87, v87, v79
    v_cvt_pk_bf16_f32 v54, v76, v77
    v_cvt_pk_bf16_f32 v55, v78, v79
    s_waitcnt vmcnt(6)
    s_cmpk_gt_u32 s42, 75
    s_cbranch_scc1 L_cu75
    s_waitcnt vmcnt(5)
L_cu75:
    s_mov_b32 s41, 274432
    buffer_load_dwordx4 v[116:119], v3, s[12:15], s41 offen nt
    v_lshlrev_b32 v76, 16, v56
    v_lshlrev_b32 v78, 16, v57
    v_and_b32 v77, 0xffff0000, v56
    v_and_b32 v79, 0xffff0000, v57
    v_sub_f32 v76, v76, v92
    v_sub_f32 v78, v78, v92
    v_sub_f32 v77, v77, v92
    v_sub_f32 v79, v79, v92
    v_mul_f32 v76, 0x3fb8aa3b, v76
    v_mul_f32 v78, 0x3fb8aa3b, v78
    v_mul_f32 v77, 0x3fb8aa3b, v77
    v_mul_f32 v79, 0x3fb8aa3b, v79
    v_exp_f32 v76, v76
    v_exp_f32 v78, v78
    v_exp_f32 v77, v77
    v_exp_f32 v79, v79
    v_add_f32 v93, v93, v76
    v_add_f32 v93, v93, v78
    v_add_f32 v87, v87, v77
    v_add_f32 v87, v87, v79
    v_cvt_pk_bf16_f32 v56, v76, v77
    v_cvt_pk_bf16_f32 v57, v78, v79
    v_lshlrev_b32 v76, 16, v58
    v_lshlrev_b32 v78, 16, v59
    v_and_b32 v77, 0xffff0000, v58
    v_and_b32 v79, 0xffff0000, v59
    v_sub_f32 v76, v76, v92
    v_sub_f32 v78, v78, v92
    v_sub_f32 v77, v77, v92
    v_sub_f32 v79, v79, v92
    v_mul_f32 v76, 0x3fb8aa3b, v76
    v_mul_f32 v78, 0x3fb8aa3b, v78
    v_mul_f32 v77, 0x3fb8aa3b, v77
    v_mul_f32 v79, 0x3fb8aa3b, v79
    v_exp_f32 v76, v76
    v_exp_f32 v78, v78
    v_exp_f32 v77, v77
    v_exp_f32 v79, v79
    v_add_f32 v93, v93, v76
    v_add_f32 v93, v93, v78
    v_add_f32 v87, v87, v77
    v_add_f32 v87, v87, v79
    v_cvt_pk_bf16_f32 v58, v76, v77
    v_cvt_pk_bf16_f32 v59, v78, v79
    s_waitcnt vmcnt(6)
    s_cmpk_gt_u32 s42, 76
    s_cbranch_scc1 L_cu76
    s_waitcnt vmcnt(4)
L_cu76:
    s_mov_b32 s41, 278528
    buffer_load_dwordx4 v[120:123], v3, s[12:15], s41 offen nt
    v_lshlrev_b32 v76, 16, v60
    v_lshlrev_b32 v78, 16, v61
    v_and_b32 v77, 0xffff0000, v60
    v_and_b32 v79, 0xffff0000, v61
    v_sub_f32 v76, v76, v92
    v_sub_f32 v78, v78, v92
    v_sub_f32 v77, v77, v92
    v_sub_f32 v79, v79, v92
    v_mul_f32 v76, 0x3fb8aa3b, v76
    v_mul_f32 v78, 0x3fb8aa3b, v78
    v_mul_f32 v77, 0x3fb8aa3b, v77
    v_mul_f32 v79, 0x3fb8aa3b, v79
    v_exp_f32 v76, v76
    v_exp_f32 v78, v78
    v_exp_f32 v77, v77
    v_exp_f32 v79, v79
    v_add_f32 v93, v93, v76
    v_add_f32 v93, v93, v78
    v_add_f32 v87, v87, v77
    v_add_f32 v87, v87, v79
    v_cvt_pk_bf16_f32 v60, v76, v77
    v_cvt_pk_bf16_f32 v61, v78, v79
    v_lshlrev_b32 v76, 16, v62
    v_lshlrev_b32 v78, 16, v63
    v_and_b32 v77, 0xffff0000, v62
    v_and_b32 v79, 0xffff0000, v63
    v_sub_f32 v76, v76, v92
    v_sub_f32 v78, v78, v92
    v_sub_f32 v77, v77, v92
    v_sub_f32 v79, v79, v92
    v_mul_f32 v76, 0x3fb8aa3b, v76
    v_mul_f32 v78, 0x3fb8aa3b, v78
    v_mul_f32 v77, 0x3fb8aa3b, v77
    v_mul_f32 v79, 0x3fb8aa3b, v79
    v_exp_f32 v76, v76
    v_exp_f32 v78, v78
    v_exp_f32 v77, v77
    v_exp_f32 v79, v79
    v_add_f32 v93, v93, v76
    v_add_f32 v93, v93, v78
    v_add_f32 v87, v87, v77
    v_add_f32 v87, v87, v79
    v_cvt_pk_bf16_f32 v62, v76, v77
    v_cvt_pk_bf16_f32 v63, v78, v79
    s_waitcnt vmcnt(6)
    s_cmpk_gt_u32 s42, 77
    s_cbranch_scc1 L_cu77
    s_waitcnt vmcnt(4)
L_cu77:
    s_mov_b32 s41, 282624
    buffer_load_dwordx4 v[124:127], v3, s[12:15], s41 offen nt
    v_lshlrev_b32 v76, 16, v64
    v_lshlrev_b32 v78, 16, v65
    v_and_b32 v77, 0xffff0000, v64
    v_and_b32 v79, 0xffff0000, v65
    v_sub_f32 v76, v76, v92
    v_sub_f32 v78, v78, v92
    v_sub_f32 v77, v77, v92
    v_sub_f32 v79, v79, v92
    v_mul_f32 v76, 0x3fb8aa3b, v76
    v_mul_f32 v78, 0x3fb8aa3b, v78
    v_mul_f32 v77, 0x3fb8aa3b, v77
    v_mul_f32 v79, 0x3fb8aa3b, v79
    v_exp_f32 v76, v76
    v_exp_f32 v78, v78
    v_exp_f32 v77, v77
    v_exp_f32 v79, v79
    v_add_f32 v93, v93, v76
    v_add_f32 v93, v93, v78
    v_add_f32 v87, v87, v77
    v_add_f32 v87, v87, v79
    v_cvt_pk_bf16_f32 v64, v76, v77
    v_cvt_pk_bf16_f32 v65, v78, v79
    v_lshlrev_b32 v76, 16, v66
    v_lshlrev_b32 v78, 16, v67
    v_and_b32 v77, 0xffff0000, v66
    v_and_b32 v79, 0xffff0000, v67
    v_sub_f32 v76, v76, v92
    v_sub_f32 v78, v78, v92
    v_sub_f32 v77, v77, v92
    v_sub_f32 v79, v79, v92
    v_mul_f32 v76, 0x3fb8aa3b, v76
    v_mul_f32 v78, 0x3fb8aa3b, v78
    v_mul_f32 v77, 0x3fb8aa3b, v77
    v_mul_f32 v79, 0x3fb8aa3b, v79
    v_exp_f32 v76, v76
    v_exp_f32 v78, v78
    v_exp_f32 v77, v77
    v_exp_f32 v79, v79
    v_add_f32 v93, v93, v76
    v_add_f32 v93, v93, v78
    v_add_f32 v87, v87, v77
    v_add_f32 v87, v87, v79
    v_cvt_pk_bf16_f32 v66, v76, v77
    v_cvt_pk_bf16_f32 v67, v78, v79
    s_waitcnt vmcnt(6)
    s_cmpk_gt_u32 s42, 78
    s_cbranch_scc1 L_cu78
    s_waitcnt vmcnt(4)
L_cu78:
    s_mov_b32 s41, 286720
    buffer_load_dwordx4 v[128:131], v3, s[12:15], s41 offen nt
    v_lshlrev_b32 v76, 16, v68
    v_lshlrev_b32 v78, 16, v69
    v_and_b32 v77, 0xffff0000, v68
    v_and_b32 v79, 0xffff0000, v69
    v_sub_f32 v76, v76, v92
    v_sub_f32 v78, v78, v92
    v_sub_f32 v77, v77, v92
    v_sub_f32 v79, v79, v92
    v_mul_f32 v76, 0x3fb8aa3b, v76
    v_mul_f32 v78, 0x3fb8aa3b, v78
    v_mul_f32 v77, 0x3fb8aa3b, v77
    v_mul_f32 v79, 0x3fb8aa3b, v79
    v_exp_f32 v76, v76
    v_exp_f32 v78, v78
    v_exp_f32 v77, v77
    v_exp_f32 v79, v79
    v_add_f32 v93, v93, v76
    v_add_f32 v93, v93, v78
    v_add_f32 v87, v87, v77
    v_add_f32 v87, v87, v79
    v_cvt_pk_bf16_f32 v68, v76, v77
    v_cvt_pk_bf16_f32 v69, v78, v79
    v_lshlrev_b32 v76, 16, v70
    v_lshlrev_b32 v78, 16, v71
    v_and_b32 v77, 0xffff0000, v70
    v_and_b32 v79, 0xffff0000, v71
    v_sub_f32 v76, v76, v92
    v_sub_f32 v78, v78, v92
    v_sub_f32 v77, v77, v92
    v_sub_f32 v79, v79, v92
    v_mul_f32 v76, 0x3fb8aa3b, v76
    v_mul_f32 v78, 0x3fb8aa3b, v78
    v_mul_f32 v77, 0x3fb8aa3b, v77
    v_mul_f32 v79, 0x3fb8aa3b, v79
    v_exp_f32 v76, v76
    v_exp_f32 v78, v78
    v_exp_f32 v77, v77
    v_exp_f32 v79, v79
    v_add_f32 v93, v93, v76
    v_add_f32 v93, v93, v78
    v_add_f32 v87, v87, v77
    v_add_f32 v87, v87, v79
    v_cvt_pk_bf16_f32 v70, v76, v77
    v_cvt_pk_bf16_f32 v71, v78, v79
    s_waitcnt vmcnt(6)
    s_cmpk_gt_u32 s42, 79
    s_cbranch_scc1 L_cu79
    s_waitcnt vmcnt(4)
L_cu79:
    s_mov_b32 s41, 290816
    buffer_load_dwordx4 v[132:135], v3, s[12:15], s41 offen nt
    v_lshlrev_b32 v76, 16, v72
    v_lshlrev_b32 v78, 16, v73
    v_and_b32 v77, 0xffff0000, v72
    v_and_b32 v79, 0xffff0000, v73
    v_sub_f32 v76, v76, v92
    v_sub_f32 v78, v78, v92
    v_sub_f32 v77, v77, v92
    v_sub_f32 v79, v79, v92
    v_mul_f32 v76, 0x3fb8aa3b, v76
    v_mul_f32 v78, 0x3fb8aa3b, v78
    v_mul_f32 v77, 0x3fb8aa3b, v77
    v_mul_f32 v79, 0x3fb8aa3b, v79
    v_exp_f32 v76, v76
    v_exp_f32 v78, v78
    v_exp_f32 v77, v77
    v_exp_f32 v79, v79
    v_add_f32 v93, v93, v76
    v_add_f32 v93, v93, v78
    v_add_f32 v87, v87, v77
    v_add_f32 v87, v87, v79
    v_cvt_pk_bf16_f32 v72, v76, v77
    v_cvt_pk_bf16_f32 v73, v78, v79
    v_lshlrev_b32 v76, 16, v74
    v_lshlrev_b32 v78, 16, v75
    v_and_b32 v77, 0xffff0000, v74
    v_and_b32 v79, 0xffff0000, v75
    v_sub_f32 v76, v76, v92
    v_sub_f32 v78, v78, v92
    v_sub_f32 v77, v77, v92
    v_sub_f32 v79, v79, v92
    v_mul_f32 v76, 0x3fb8aa3b, v76
    v_mul_f32 v78, 0x3fb8aa3b, v78
    v_mul_f32 v77, 0x3fb8aa3b, v77
    v_mul_f32 v79, 0x3fb8aa3b, v79
    v_exp_f32 v76, v76
    v_exp_f32 v78, v78
    v_exp_f32 v77, v77
    v_exp_f32 v79, v79
    v_add_f32 v93, v93, v76
    v_add_f32 v93, v93, v78
    v_add_f32 v87, v87, v77
    v_add_f32 v87, v87, v79
    v_cvt_pk_bf16_f32 v74, v76, v77
    v_cvt_pk_bf16_f32 v75, v78, v79
    s_waitcnt vmcnt(6)
    s_cmpk_gt_u32 s42, 80
    s_cbranch_scc1 L_cu80
    s_waitcnt vmcnt(4)
L_cu80:
    s_mov_b32 s41, 32768
    buffer_load_dwordx4 v[136:139], v3, s[12:15], s41 offen nt
    v_add_f32 v93, v93, v87
    s_lshl_b32 s43, s3, 4
    v_and_or_b32 v99, v0, 8, s43
    v_lshrrev_b32 v100, 5, v0
    v_lshlrev_b32 v100, 3, v100
    v_mov_b32 v84, v93
    s_nop 1
    v_permlane16_swap_b32 v93, v84
    v_add_f32 v93, v93, v84
    v_mov_b32 v84, v93
    s_nop 1
    v_permlane32_swap_b32 v93, v84
    v_add_f32 v93, v93, v84
    ds_write_b64 v99, v[92:93] offset:0
    v_add_u32 v99, s43, v100
    v_perm_b32 v12, v44, v44, v4
    v_perm_b32 v13, v44, v44, v5
    v_perm_b32 v14, v44, v44, v6
    v_perm_b32 v15, v44, v44, v7
    v_perm_b32 v16, v44, v44, v8
    v_perm_b32 v17, v44, v44, v9
    v_mfma_f32_16x16x32_bf16 v[20:23], v[12:15], v[216:219], 0
    v_perm_b32 v18, v44, v44, v10
    v_perm_b32 v19, v44, v44, v11
    v_perm_b32 v12, v45, v45, v4
    v_perm_b32 v13, v45, v45, v5
    v_mfma_f32_16x16x32_bf16 v[20:23], v[16:19], v[220:223], v[20:23]
    v_perm_b32 v14, v45, v45, v6
    v_perm_b32 v15, v45, v45, v7
    v_perm_b32 v16, v45, v45, v8
    v_perm_b32 v17, v45, v45, v9
    v_mfma_f32_16x16x32_bf16 v[20:23], v[12:15], v[224:227], v[20:23]
    v_perm_b32 v18, v45, v45, v10
    v_perm_b32 v19, v45, v45, v11
    v_perm_b32 v12, v46, v46, v4
    v_perm_b32 v13, v46, v46, v5
    v_mfma_f32_16x16x32_bf16 v[20:23], v[16:19], v[228:231], v[20:23]
    v_perm_b32 v14, v46, v46, v6
    v_perm_b32 v15, v46, v46, v7
    s_waitcnt vmcnt(6)
    s_cmpk_gt_u32 s42, 81
    s_cbranch_scc1 L_cu81
    s_waitcnt vmcnt(4)
L_cu81:
    s_mov_b32 s41, 36864
    buffer_load_dwordx4 v[140:143], v3, s[12:15], s41 offen nt
    v_perm_b32 v16, v46, v46, v8
    v_perm_b32 v17, v46, v46, v9
    v_mfma_f32_16x16x32_bf16 v[20:23], v[12:15], v[232:235], v[20:23]
    v_perm_b32 v18, v46, v46, v10
    v_perm_b32 v19, v46, v46, v11
    v_perm_b32 v12, v47, v47, v4
    v_perm_b32 v13, v47, v47, v5
    v_mfma_f32_16x16x32_bf16 v[20:23], v[16:19], v[236:239], v[20:23]
    v_perm_b32 v14, v47, v47, v6
    v_perm_b32 v15, v47, v47, v7
    v_perm_b32 v16, v47, v47, v8
    v_perm_b32 v17, v47, v47, v9
    v_mfma_f32_16x16x32_bf16 v[20:23], v[12:15], v[240:243], v[20:23]
    v_perm_b32 v18, v47, v47, v10
    v_perm_b32 v19, v47, v47, v11
    v_perm_b32 v12, v48, v48, v4
    v_perm_b32 v13, v48, v48, v5
    v_mfma_f32_16x16x32_bf16 v[20:23], v[16:19], v[244:247], v[20:23]
    v_perm_b32 v14, v48, v48, v6
    v_perm_b32 v15, v48, v48, v7
    v_perm_b32 v16, v48, v48, v8
    v_perm_b32 v17, v48, v48, v9
    v_mfma_f32_16x16x32_bf16 v[20:23], v[12:15], v[104:107], v[20:23]
    v_perm_b32 v18, v48, v48, v10
    v_perm_b32 v19, v48, v48, v11
    v_perm_b32 v12, v49, v49, v4
    v_perm_b32 v13, v49, v49, v5
    v_mfma_f32_16x16x32_bf16 v[20:23], v[16:19], v[108:111], v[20:23]
    v_perm_b32 v14, v49, v49, v6
    v_perm_b32 v15, v49, v49, v7
    v_perm_b32 v16, v49, v49, v8
    v_perm_b32 v17, v49, v49, v9
    v_mfma_f32_16x16x32_bf16 v[20:23], v[12:15], v[112:115], v[20:23]
    v_perm_b32 v18, v49, v49, v10
    v_perm_b32 v19, v49, v49, v11
    s_waitcnt vmcnt(6)
    s_cmpk_gt_u32 s42, 82
    s_cbranch_scc1 L_cu82
    s_waitcnt vmcnt(4)
L_cu82:
    s_mov_b32 s41, 40960
    buffer_load_dwordx4 v[144:147], v3, s[12:15], s41 offen nt
    v_perm_b32 v12, v50, v50, v4
    v_perm_b32 v13, v50, v50, v5
    v_mfma_f32_16x16x32_bf16 v[20:23], v[16:19], v[116:119], v[20:23]
    v_perm_b32 v14, v50, v50, v6
    v_perm_b32 v15, v50, v50, v7
    s_waitcnt vmcnt(6)
    s_cmpk_gt_u32 s42, 83
    s_cbranch_scc1 L_cu83
    s_waitcnt vmcnt(4)
L_cu83:
    s_mov_b32 s41, 45056
    buffer_load_dwordx4 v[148:151], v3, s[12:15], s41 offen nt
    v_perm_b32 v16, v50, v50, v8
    v_perm_b32 v17, v50, v50, v9
    v_mfma_f32_16x16x32_bf16 v[20:23], v[12:15], v[120:123], v[20:23]
    v_perm_b32 v18, v50, v50, v10
    v_perm_b32 v19, v50, v50, v11
    s_waitcnt vmcnt(6)
    s_cmpk_gt_u32 s42, 84
    s_cbranch_scc1 L_cu84
    s_waitcnt vmcnt(4)
L_cu84:
    s_mov_b32 s41, 49152
    buffer_load_dwordx4 v[152:155], v3, s[12:15], s41 offen nt
    v_perm_b32 v12, v51, v51, v4
    v_perm_b32 v13, v51, v51, v5
    v_mfma_f32_16x16x32_bf16 v[20:23], v[16:19], v[124:127], v[20:23]
    v_perm_b32 v14, v51, v51, v6
    v_perm_b32 v15, v51, v51, v7
    s_waitcnt vmcnt(6)
    s_cmpk_gt_u32 s42, 85
    s_cbranch_scc1 L_cu85
    s_waitcnt vmcnt(4)
L_cu85:
    s_mov_b32 s41, 53248
    buffer_load_dwordx4 v[156:159], v3, s[12:15], s41 offen nt
    v_perm_b32 v16, v51, v51, v8
    v_perm_b32 v17, v51, v51, v9
    v_mfma_f32_16x16x32_bf16 v[20:23], v[12:15], v[128:131], v[20:23]
    v_perm_b32 v18, v51, v51, v10
    v_perm_b32 v19, v51, v51, v11
    s_waitcnt vmcnt(6)
    ds_read_b32 v101, v91 offset:96
    s_cmpk_gt_u32 s42, 86
    s_cbranch_scc1 L_cu86
    s_waitcnt vmcnt(4)
L_cu86:
    s_mov_b32 s41, 57344
    buffer_load_dwordx4 v[160:163], v3, s[12:15], s41 offen nt
    v_perm_b32 v12, v52, v52, v4
    v_perm_b32 v13, v52, v52, v5
    v_mfma_f32_16x16x32_bf16 v[20:23], v[16:19], v[132:135], v[20:23]
    v_perm_b32 v14, v52, v52, v6
    v_perm_b32 v15, v52, v52, v7
    s_waitcnt vmcnt(6)
    s_waitcnt lgkmcnt(0)
    v_readfirstlane_b32 s42, v101
    s_nop 0
    s_cmpk_gt_u32 s42, 87
    s_cbranch_scc1 L_cu87
    s_waitcnt vmcnt(4)
L_cu87:
    s_mov_b32 s41, 61440
    buffer_load_dwordx4 v[164:167], v3, s[12:15], s41 offen nt
    v_perm_b32 v16, v52, v52, v8
    v_perm_b32 v17, v52, v52, v9
    v_mfma_f32_16x16x32_bf16 v[20:23], v[12:15], v[136:139], v[20:23]
    v_perm_b32 v18, v52, v52, v10
    v_perm_b32 v19, v52, v52, v11
    s_waitcnt vmcnt(6)
    s_cmpk_gt_u32 s42, 88
    s_cbranch_scc1 L_cu88
    s_waitcnt vmcnt(4)
L_cu88:
    s_mov_b32 s41, 294912
    buffer_load_dwordx4 v[168:171], v3, s[12:15], s41 offen nt
    v_perm_b32 v12, v53, v53, v4
    v_perm_b32 v13, v53, v53, v5
    v_mfma_f32_16x16x32_bf16 v[20:23], v[16:19], v[140:143], v[20:23]
    v_perm_b32 v14, v53, v53, v6
    v_perm_b32 v15, v53, v53, v7
    s_waitcnt vmcnt(6)
    s_cmpk_gt_u32 s42, 89
    s_cbranch_scc1 L_cu89
    s_waitcnt vmcnt(4)
L_cu89:
    s_mov_b32 s41, 299008
    buffer_load_dwordx4 v[172:175], v3, s[12:15], s41 offen nt
    v_perm_b32 v16, v53, v53, v8
    v_perm_b32 v17, v53, v53, v9
    v_mfma_f32_16x16x32_bf16 v[20:23], v[12:15], v[144:147], v[20:23]
    v_perm_b32 v18, v53, v53, v10
    v_perm_b32 v19, v53, v53, v11
    s_waitcnt vmcnt(6)
    ds_read_b32 v101, v91 offset:96
    s_cmpk_gt_u32 s42, 90
    s_cbranch_scc1 L_cu90
    s_waitcnt vmcnt(4)
L_cu90:
    s_mov_b32 s41, 303104
    buffer_load_dwordx4 v[176:179], v3, s[12:15], s41 offen nt
    v_perm_b32 v12, v54, v54, v4
    v_perm_b32 v13, v54, v54, v5
    v_mfma_f32_16x16x32_bf16 v[20:23], v[16:19], v[148:151], v[20:23]
    v_perm_b32 v14, v54, v54, v6
    v_perm_b32 v15, v54, v54, v7
    s_waitcnt vmcnt(6)
    s_waitcnt lgkmcnt(0)
    v_readfirstlane_b32 s42, v101
    s_nop 0
    s_cmpk_gt_u32 s42, 91
    s_cbranch_scc1 L_cu91
    s_waitcnt vmcnt(4)
L_cu91:
    s_mov_b32 s41, 307200
    buffer_load_dwordx4 v[180:183], v3, s[12:15], s41 offen nt
    v_perm_b32 v16, v54, v54, v8
    v_perm_b32 v17, v54, v54, v9
    v_mfma_f32_16x16x32_bf16 v[20:23], v[12:15], v[152:155], v[20:23]
    v_perm_b32 v18, v54, v54, v10
    v_perm_b32 v19, v54, v54, v11
    s_waitcnt vmcnt(6)
    s_cmpk_gt_u32 s42, 92
    s_cbranch_scc1 L_cu92
    s_waitcnt vmcnt(4)
L_cu92:
    s_mov_b32 s41, 311296
    buffer_load_dwordx4 v[184:187], v3, s[12:15], s41 offen nt
    v_perm_b32 v12, v55, v55, v4
    v_perm_b32 v13, v55, v55, v5
    v_mfma_f32_16x16x32_bf16 v[20:23], v[16:19], v[156:159], v[20:23]
    v_perm_b32 v14, v55, v55, v6
    v_perm_b32 v15, v55, v55, v7
    s_waitcnt vmcnt(6)
    s_cmpk_gt_u32 s42, 93
    s_cbranch_scc1 L_cu93
    s_waitcnt vmcnt(4)
L_cu93:
    s_mov_b32 s41, 315392
    buffer_load_dwordx4 v[188:191], v3, s[12:15], s41 offen nt
    v_perm_b32 v16, v55, v55, v8
    v_perm_b32 v17, v55, v55, v9
    v_mfma_f32_16x16x32_bf16 v[20:23], v[12:15], v[160:163], v[20:23]
    v_perm_b32 v18, v55, v55, v10
    v_perm_b32 v19, v55, v55, v11
    s_waitcnt vmcnt(6)
    ds_read_b32 v101, v91 offset:96
    s_cmpk_gt_u32 s42, 94
    s_cbranch_scc1 L_cu94
    s_waitcnt vmcnt(4)
L_cu94:
    s_mov_b32 s41, 319488
    buffer_load_dwordx4 v[192:195], v3, s[12:15], s41 offen nt
    v_perm_b32 v12, v56, v56, v4
    v_perm_b32 v13, v56, v56, v5
    v_mfma_f32_16x16x32_bf16 v[20:23], v[16:19], v[164:167], v[20:23]
    v_perm_b32 v14, v56, v56, v6
    v_perm_b32 v15, v56, v56, v7
    s_waitcnt vmcnt(6)
    s_waitcnt lgkmcnt(0)
    v_readfirstlane_b32 s42, v101
    s_nop 0
    s_cmpk_gt_u32 s42, 95
    s_cbranch_scc1 L_cu95
    s_waitcnt vmcnt(4)
L_cu95:
    s_mov_b32 s41, 323584
    buffer_load_dwordx4 v[196:199], v3, s[12:15], s41 offen nt
    v_perm_b32 v16, v56, v56, v8
    v_perm_b32 v17, v56, v56, v9
    v_mfma_f32_16x16x32_bf16 v[20:23], v[12:15], v[168:171], v[20:23]
    v_perm_b32 v18, v56, v56, v10
    v_perm_b32 v19, v56, v56, v11
    s_waitcnt vmcnt(6)
    v_xor_b32 v3, 0x200000, v3
    s_cmpk_gt_u32 s42, 96
    s_cbranch_scc1 L_cu96
    s_waitcnt vmcnt(4)
L_cu96:
    s_mov_b32 s41, 131072
    buffer_load_dwordx4 v[200:203], v3, s[12:15], s41 offen nt
    v_perm_b32 v12, v57, v57, v4
    v_perm_b32 v13, v57, v57, v5
    v_mfma_f32_16x16x32_bf16 v[20:23], v[16:19], v[172:175], v[20:23]
    v_perm_b32 v14, v57, v57, v6
    v_perm_b32 v15, v57, v57, v7
    s_waitcnt vmcnt(6)
    s_cmpk_gt_u32 s42, 97
    s_cbranch_scc1 L_cu97
    s_waitcnt vmcnt(4)
L_cu97:
    s_mov_b32 s41, 135168
    buffer_load_dwordx4 v[204:207], v3, s[12:15], s41 offen nt
    v_perm_b32 v16, v57, v57, v8
    v_perm_b32 v17, v57, v57, v9
    v_mfma_f32_16x16x32_bf16 v[20:23], v[12:15], v[176:179], v[20:23]
    v_perm_b32 v18, v57, v57, v10
    v_perm_b32 v19, v57, v57, v11
    s_waitcnt vmcnt(6)
    s_cmpk_gt_u32 s42, 98
    s_cbranch_scc1 L_cu98
    s_waitcnt vmcnt(4)
L_cu98:
    s_mov_b32 s41, 139264
    buffer_load_dwordx4 v[208:211], v3, s[12:15], s41 offen nt
    v_perm_b32 v12, v58, v58, v4
    v_perm_b32 v13, v58, v58, v5
    v_mfma_f32_16x16x32_bf16 v[20:23], v[16:19], v[180:183], v[20:23]
    v_perm_b32 v14, v58, v58, v6
    v_perm_b32 v15, v58, v58, v7
    s_waitcnt vmcnt(6)
    s_cmpk_gt_u32 s42, 99
    s_cbranch_scc1 L_cu99
    s_waitcnt vmcnt(4)
L_cu99:
    s_mov_b32 s41, 143360
    buffer_load_dwordx4 v[212:215], v3, s[12:15], s41 offen nt
    v_perm_b32 v16, v58, v58, v8
    v_perm_b32 v17, v58, v58, v9
    v_mfma_f32_16x16x32_bf16 v[20:23], v[12:15], v[184:187], v[20:23]
    v_perm_b32 v18, v58, v58, v10
    v_perm_b32 v19, v58, v58, v11
    s_waitcnt vmcnt(6)
    s_cmpk_gt_u32 s42, 100
    s_cbranch_scc1 L_cu100
    s_waitcnt vmcnt(4)
L_cu100:
    s_mov_b32 s41, 147456
    buffer_load_dwordx4 v[216:219], v3, s[12:15], s41 offen nt
    v_perm_b32 v12, v59, v59, v4
    v_perm_b32 v13, v59, v59, v5
    v_mfma_f32_16x16x32_bf16 v[20:23], v[16:19], v[188:191], v[20:23]
    v_perm_b32 v14, v59, v59, v6
    v_perm_b32 v15, v59, v59, v7
    s_waitcnt vmcnt(6)
    s_cmpk_gt_u32 s42, 101
    s_cbranch_scc1 L_cu101
    s_waitcnt vmcnt(4)
L_cu101:
    s_mov_b32 s41, 151552
    buffer_load_dwordx4 v[220:223], v3, s[12:15], s41 offen nt
    v_perm_b32 v16, v59, v59, v8
    v_perm_b32 v17, v59, v59, v9
    v_mfma_f32_16x16x32_bf16 v[20:23], v[12:15], v[192:195], v[20:23]
    v_perm_b32 v18, v59, v59, v10
    v_perm_b32 v19, v59, v59, v11
    s_waitcnt vmcnt(6)
    s_cmpk_gt_u32 s42, 102
    s_cbranch_scc1 L_cu102
    s_waitcnt vmcnt(4)
L_cu102:
    s_mov_b32 s41, 155648
    buffer_load_dwordx4 v[224:227], v3, s[12:15], s41 offen nt
    v_perm_b32 v12, v60, v60, v4
    v_perm_b32 v13, v60, v60, v5
    v_mfma_f32_16x16x32_bf16 v[20:23], v[16:19], v[196:199], v[20:23]
    v_perm_b32 v14, v60, v60, v6
    v_perm_b32 v15, v60, v60, v7
    s_waitcnt vmcnt(6)
    s_cmpk_gt_u32 s42, 103
    s_cbranch_scc1 L_cu103
    s_waitcnt vmcnt(4)
L_cu103:
    s_mov_b32 s41, 159744
    buffer_load_dwordx4 v[228:231], v3, s[12:15], s41 offen nt
    v_perm_b32 v16, v60, v60, v8
    v_perm_b32 v17, v60, v60, v9
    v_mfma_f32_16x16x32_bf16 v[20:23], v[12:15], v[200:203], v[20:23]
    v_perm_b32 v18, v60, v60, v10
    v_perm_b32 v19, v60, v60, v11
    s_waitcnt vmcnt(6)
    v_mov_b32 v101, 1
    s_mov_b64 exec, 1
    ds_add_rtn_u32 v101, v91, v101 offset:104
    s_mov_b64 exec, -1
    s_cmpk_gt_u32 s42, 104
    s_cbranch_scc1 L_cu104
    s_waitcnt vmcnt(4)
L_cu104:
    s_mov_b32 s41, 393216
    buffer_load_dwordx4 v[232:235], v3, s[12:15], s41 offen nt
    v_perm_b32 v12, v61, v61, v4
    v_perm_b32 v13, v61, v61, v5
    v_mfma_f32_16x16x32_bf16 v[20:23], v[16:19], v[204:207], v[20:23]
    v_perm_b32 v14, v61, v61, v6
    v_perm_b32 v15, v61, v61, v7
    s_waitcnt vmcnt(6)
    s_waitcnt lgkmcnt(0)
    v_readfirstlane_b32 s43, v101
    s_max_u32 s42, s42, 105
    s_mul_i32 s44, s43, 3
    s_add_u32 s42, s42, s44
    s_cmpk_gt_u32 s42, 105
    s_cbranch_scc1 L_cu105
    s_waitcnt vmcnt(4)
L_cu105:
    s_mov_b32 s41, 397312
    buffer_load_dwordx4 v[236:239], v3, s[12:15], s41 offen nt
    v_perm_b32 v16, v61, v61, v8
    v_perm_b32 v17, v61, v61, v9
    v_mfma_f32_16x16x32_bf16 v[20:23], v[12:15], v[208:211], v[20:23]
    v_perm_b32 v18, v61, v61, v10
    v_perm_b32 v19, v61, v61, v11
    s_waitcnt vmcnt(6)
    s_cmpk_gt_u32 s42, 106
    s_cbranch_scc1 L_cu106
    s_waitcnt vmcnt(4)
L_cu106:
    s_mov_b32 s41, 401408
    buffer_load_dwordx4 v[240:243], v3, s[12:15], s41 offen nt
    v_perm_b32 v12, v62, v62, v4
    v_perm_b32 v13, v62, v62, v5
    v_mfma_f32_16x16x32_bf16 v[20:23], v[16:19], v[212:215], v[20:23]
    v_perm_b32 v14, v62, v62, v6
    v_perm_b32 v15, v62, v62, v7
    s_waitcnt vmcnt(6)
    s_cmpk_gt_u32 s42, 107
    s_cbranch_scc1 L_cu107
    s_waitcnt vmcnt(4)
L_cu107:
    s_mov_b32 s41, 405504
    buffer_load_dwordx4 v[244:247], v3, s[12:15], s41 offen nt
    v_perm_b32 v16, v62, v62, v8
    v_perm_b32 v17, v62, v62, v9
    v_mfma_f32_16x16x32_bf16 v[20:23], v[12:15], v[216:219], v[20:23]
    v_perm_b32 v18, v62, v62, v10
    v_perm_b32 v19, v62, v62, v11
    s_waitcnt vmcnt(6)
    s_cmpk_gt_u32 s42, 108
    s_cbranch_scc1 L_cu108
    s_waitcnt vmcnt(4)
L_cu108:
    s_mov_b32 s41, 409600
    buffer_load_dwordx4 v[104:107], v3, s[12:15], s41 offen nt
    v_perm_b32 v12, v63, v63, v4
    v_perm_b32 v13, v63, v63, v5
    v_mfma_f32_16x16x32_bf16 v[20:23], v[16:19], v[220:223], v[20:23]
    v_perm_b32 v14, v63, v63, v6
    v_perm_b32 v15, v63, v63, v7
    s_waitcnt vmcnt(6)
    s_cmpk_gt_u32 s42, 109
    s_cbranch_scc1 L_cu109
    s_waitcnt vmcnt(4)
L_cu109:
    s_mov_b32 s41, 413696
    buffer_load_dwordx4 v[108:111], v3, s[12:15], s41 offen nt
    v_perm_b32 v16, v63, v63, v8
    v_perm_b32 v17, v63, v63, v9
    v_mfma_f32_16x16x32_bf16 v[20:23], v[12:15], v[224:227], v[20:23]
    v_perm_b32 v18, v63, v63, v10
    v_perm_b32 v19, v63, v63, v11
    s_waitcnt vmcnt(6)
    s_cmpk_gt_u32 s42, 110
    s_cbranch_scc1 L_cu110
    s_waitcnt vmcnt(4)
L_cu110:
    s_mov_b32 s41, 417792
    buffer_load_dwordx4 v[112:115], v3, s[12:15], s41 offen nt
    v_perm_b32 v12, v64, v64, v4
    v_perm_b32 v13, v64, v64, v5
    v_mfma_f32_16x16x32_bf16 v[20:23], v[16:19], v[228:231], v[20:23]
    v_perm_b32 v14, v64, v64, v6
    v_perm_b32 v15, v64, v64, v7
    s_waitcnt vmcnt(6)
    s_cmpk_gt_u32 s42, 111
    s_cbranch_scc1 L_cu111
    s_waitcnt vmcnt(4)
L_cu111:
    s_mov_b32 s41, 421888
    buffer_load_dwordx4 v[116:119], v3, s[12:15], s41 offen nt
    v_perm_b32 v16, v64, v64, v8
    v_perm_b32 v17, v64, v64, v9
    v_mfma_f32_16x16x32_bf16 v[20:23], v[12:15], v[232:235], v[20:23]
    v_perm_b32 v18, v64, v64, v10
    v_perm_b32 v19, v64, v64, v11
    s_waitcnt vmcnt(6)
    s_cmpk_gt_u32 s42, 112
    s_cbranch_scc1 L_cu112
    s_waitcnt vmcnt(4)
L_cu112:
    s_mov_b32 s41, 163840
    buffer_load_dwordx4 v[120:123], v3, s[12:15], s41 offen nt
    v_perm_b32 v12, v65, v65, v4
    v_perm_b32 v13, v65, v65, v5
    v_mfma_f32_16x16x32_bf16 v[20:23], v[16:19], v[236:239], v[20:23]
    v_perm_b32 v14, v65, v65, v6
    v_perm_b32 v15, v65, v65, v7
    s_waitcnt vmcnt(6)
    s_cmpk_gt_u32 s42, 113
    s_cbranch_scc1 L_cu113
    s_waitcnt vmcnt(4)
L_cu113:
    s_mov_b32 s41, 167936
    buffer_load_dwordx4 v[124:127], v3, s[12:15], s41 offen nt
    v_perm_b32 v16, v65, v65, v8
    v_perm_b32 v17, v65, v65, v9
    v_mfma_f32_16x16x32_bf16 v[20:23], v[12:15], v[240:243], v[20:23]
    v_perm_b32 v18, v65, v65, v10
    v_perm_b32 v19, v65, v65, v11
    s_waitcnt vmcnt(6)
    s_cmpk_gt_u32 s42, 114
    s_cbranch_scc1 L_cu114
    s_waitcnt vmcnt(4)
L_cu114:
    s_mov_b32 s41, 172032
    buffer_load_dwordx4 v[128:131], v3, s[12:15], s41 offen nt
    v_perm_b32 v12, v66, v66, v4
    v_perm_b32 v13, v66, v66, v5
    v_mfma_f32_16x16x32_bf16 v[20:23], v[16:19], v[244:247], v[20:23]
    v_perm_b32 v14, v66, v66, v6
    v_perm_b32 v15, v66, v66, v7
    s_waitcnt vmcnt(6)
    s_cmpk_gt_u32 s42, 115
    s_cbranch_scc1 L_cu115
    s_waitcnt vmcnt(4)
L_cu115:
    s_mov_b32 s41, 176128
    buffer_load_dwordx4 v[132:135], v3, s[12:15], s41 offen nt
    v_perm_b32 v16, v66, v66, v8
    v_perm_b32 v17, v66, v66, v9
    v_mfma_f32_16x16x32_bf16 v[20:23], v[12:15], v[104:107], v[20:23]
    v_perm_b32 v18, v66, v66, v10
    v_perm_b32 v19, v66, v66, v11
    s_waitcnt vmcnt(6)
    s_cmpk_gt_u32 s42, 116
    s_cbranch_scc1 L_cu116
    s_waitcnt vmcnt(5)
L_cu116:
    s_mov_b32 s41, 180224
    buffer_load_dwordx4 v[136:139], v3, s[12:15], s41 offen nt
    v_perm_b32 v12, v67, v67, v4
    v_perm_b32 v13, v67, v67, v5
    v_mfma_f32_16x16x32_bf16 v[20:23], v[16:19], v[108:111], v[20:23]
    v_perm_b32 v14, v67, v67, v6
    v_perm_b32 v15, v67, v67, v7
    s_waitcnt vmcnt(6)
    s_cmpk_gt_u32 s42, 117
    s_cbranch_scc1 L_cu117
    s_waitcnt vmcnt(5)
L_cu117:
    s_mov_b32 s41, 184320
    buffer_load_dwordx4 v[140:143], v3, s[12:15], s41 offen nt
    v_perm_b32 v16, v67, v67, v8
    v_perm_b32 v17, v67, v67, v9
    v_mfma_f32_16x16x32_bf16 v[20:23], v[12:15], v[112:115], v[20:23]
    v_perm_b32 v18, v67, v67, v10
    v_perm_b32 v19, v67, v67, v11
    s_waitcnt vmcnt(6)
    s_cmpk_gt_u32 s42, 118
    s_cbranch_scc1 L_cu118
    s_waitcnt vmcnt(5)
L_cu118:
    s_mov_b32 s41, 188416
    buffer_load_dwordx4 v[144:147], v3, s[12:15], s41 offen nt
    v_perm_b32 v12, v68, v68, v4
    v_perm_b32 v13, v68, v68, v5
    v_mfma_f32_16x16x32_bf16 v[20:23], v[16:19], v[116:119], v[20:23]
    v_perm_b32 v14, v68, v68, v6
    v_perm_b32 v15, v68, v68, v7
    ds_read_b64 v[84:85], v100 offset:64
    ds_read_b32 v86, v99 offset:0
    ds_read_b32 v87, v91 offset:80
    s_waitcnt vmcnt(6)
    s_cmpk_gt_u32 s42, 119
    s_cbranch_scc1 L_cu119
    s_waitcnt vmcnt(5)
L_cu119:
    s_mov_b32 s41, 192512
    buffer_load_dwordx4 v[148:151], v3, s[12:15], s41 offen nt
    v_perm_b32 v16, v68, v68, v8
    v_perm_b32 v17, v68, v68, v9
    v_mfma_f32_16x16x32_bf16 v[20:23], v[12:15], v[120:123], v[20:23]
    v_perm_b32 v18, v68, v68, v10
    v_perm_b32 v19, v68, v68, v11
    s_waitcnt lgkmcnt(0)
    s_mov_b32 s47, 0
L_fl_chk:
    v_cmp_eq_u32 vcc, 0, v85
    s_cbranch_vccnz L_fl_retry
L_fl_ok:
    v_sub_f32 v84, v86, v84
    v_mul_f32 v84, 0x3fb8aa3b, v84
    v_exp_f32 v84, v84
    v_lshrrev_b32 v99, 3, v0
    v_mul_f32 v94, v84, v85
    v_lshlrev_b32 v99, 5, v99
    v_readfirstlane_b32 s93, v87
    s_nop 0
    s_xor_b32 s50, s50, s93
    s_waitcnt vmcnt(6)
    s_cmpk_gt_u32 s42, 120
    s_cbranch_scc1 L_cu120
    s_waitcnt vmcnt(5)
L_cu120:
    s_mov_b32 s41, 425984
    buffer_load_dwordx4 v[152:155], v3, s[12:15], s41 offen nt
    v_perm_b32 v12, v69, v69, v4
    v_perm_b32 v13, v69, v69, v5
    v_mfma_f32_16x16x32_bf16 v[20:23], v[16:19], v[124:127], v[20:23]
    v_perm_b32 v14, v69, v69, v6
    v_perm_b32 v15, v69, v69, v7
    s_waitcnt vmcnt(6)
    s_cmpk_gt_u32 s42, 121
    s_cbranch_scc1 L_cu121
    s_waitcnt vmcnt(5)
L_cu121:
    s_mov_b32 s41, 430080
    buffer_load_dwordx4 v[156:159], v3, s[12:15], s41 offen nt
    v_perm_b32 v16, v69, v69, v8
    v_perm_b32 v17, v69, v69, v9
    v_mfma_f32_16x16x32_bf16 v[20:23], v[12:15], v[128:131], v[20:23]
    v_perm_b32 v18, v69, v69, v10
    v_perm_b32 v19, v69, v69, v11
    s_waitcnt vmcnt(6)
    s_cmpk_gt_u32 s42, 122
    s_cbranch_scc1 L_cu122
    s_waitcnt vmcnt(5)
L_cu122:
    s_mov_b32 s41, 434176
    buffer_load_dwordx4 v[160:163], v3, s[12:15], s41 offen nt
    v_perm_b32 v12, v70, v70, v4
    v_perm_b32 v13, v70, v70, v5
    v_mfma_f32_16x16x32_bf16 v[20:23], v[16:19], v[132:135], v[20:23]
    v_perm_b32 v14, v70, v70, v6
    v_perm_b32 v15, v70, v70, v7
    s_waitcnt vmcnt(6)
    s_cmpk_gt_u32 s42, 123
    s_cbranch_scc1 L_cu123
    s_waitcnt vmcnt(5)
L_cu123:
    s_mov_b32 s41, 438272
    buffer_load_dwordx4 v[164:167], v3, s[12:15], s41 offen nt
    v_perm_b32 v16, v70, v70, v8
    v_perm_b32 v17, v70, v70, v9
    v_mfma_f32_16x16x32_bf16 v[20:23], v[12:15], v[136:139], v[20:23]
    v_perm_b32 v18, v70, v70, v10
    v_perm_b32 v19, v70, v70, v11
    s_waitcnt vmcnt(6)
    s_cmpk_gt_u32 s42, 124
    s_cbranch_scc1 L_cu124
    s_waitcnt vmcnt(5)
L_cu124:
    s_mov_b32 s41, 442368
    buffer_load_dwordx4 v[168:171], v3, s[12:15], s41 offen nt
    v_perm_b32 v12, v71, v71, v4
    v_perm_b32 v13, v71, v71, v5
    v_mfma_f32_16x16x32_bf16 v[20:23], v[16:19], v[140:143], v[20:23]
    v_perm_b32 v14, v71, v71, v6
    v_perm_b32 v15, v71, v71, v7
    s_waitcnt vmcnt(6)
    s_cmpk_gt_u32 s42, 125
    s_cbranch_scc1 L_cu125
    s_waitcnt vmcnt(5)
L_cu125:
    s_mov_b32 s41, 446464
    buffer_load_dwordx4 v[172:175], v3, s[12:15], s41 offen nt
    v_perm_b32 v16, v71, v71, v8
    v_perm_b32 v17, v71, v71, v9
    v_mfma_f32_16x16x32_bf16 v[20:23], v[12:15], v[144:147], v[20:23]
    v_perm_b32 v18, v71, v71, v10
    v_perm_b32 v19, v71, v71, v11
    s_waitcnt vmcnt(6)
    s_cmpk_gt_u32 s42, 126
    s_cbranch_scc1 L_cu126
    s_waitcnt vmcnt(5)
L_cu126:
    s_mov_b32 s41, 450560
    buffer_load_dwordx4 v[176:179], v3, s[12:15], s41 offen nt
    v_perm_b32 v12, v72, v72, v4
    v_perm_b32 v13, v72, v72, v5
    v_mfma_f32_16x16x32_bf16 v[20:23], v[16:19], v[148:151], v[20:23]
    v_perm_b32 v14, v72, v72, v6
    v_perm_b32 v15, v72, v72, v7
    s_waitcnt vmcnt(6)
    s_cmpk_gt_u32 s42, 127
    s_cbranch_scc1 L_cu127
    s_waitcnt vmcnt(5)
L_cu127:
    s_mov_b32 s41, 454656
    buffer_load_dwordx4 v[180:183], v3, s[12:15], s41 offen nt
    v_perm_b32 v16, v72, v72, v8
    v_perm_b32 v17, v72, v72, v9
    v_mfma_f32_16x16x32_bf16 v[20:23], v[12:15], v[152:155], v[20:23]
    v_perm_b32 v18, v72, v72, v10
    v_perm_b32 v19, v72, v72, v11
    s_cmp_eq_u32 s3, 3
    s_cbranch_scc1 L_tail_b
    s_cmp_ge_u32 s6, 30
    s_cbranch_scc1 L_tail_b
    s_cmp_lt_u32 s6, 12
    s_cbranch_scc1 L_tail_wo
    s_waitcnt vmcnt(6)
    v_perm_b32 v12, v73, v73, v4
    v_perm_b32 v13, v73, v73, v5
    v_mfma_f32_16x16x32_bf16 v[20:23], v[16:19], v[156:159], v[20:23]
    v_perm_b32 v14, v73, v73, v6
    v_perm_b32 v15, v73, v73, v7
    s_waitcnt vmcnt(5)
    buffer_load_dwordx4 v[184:187], v96, s[20:23], 0 offen offset:0 nt
    v_perm_b32 v16, v73, v73, v8
    v_perm_b32 v17, v73, v73, v9
    v_mfma_f32_16x16x32_bf16 v[20:23], v[12:15], v[160:163], v[20:23]
    v_perm_b32 v18, v73, v73, v10
    v_perm_b32 v19, v73, v73, v11
    s_waitcnt vmcnt(5)
    buffer_load_dwordx4 v[188:191], v96, s[20:23], 0 offen offset:1152 nt
    v_perm_b32 v12, v74, v74, v4
    v_perm_b32 v13, v74, v74, v5
    v_mfma_f32_16x16x32_bf16 v[20:23], v[16:19], v[164:167], v[20:23]
    v_perm_b32 v14, v74, v74, v6
    v_perm_b32 v15, v74, v74, v7
    s_waitcnt vmcnt(5)
    buffer_load_dwordx4 v[192:195], v96, s[20:23], 0 offen offset:2304 nt
    v_perm_b32 v16, v74, v74, v8
    v_perm_b32 v17, v74, v74, v9
    v_mfma_f32_16x16x32_bf16 v[20:23], v[12:15], v[168:171], v[20:23]
    v_perm_b32 v18, v74, v74, v10
    v_perm_b32 v19, v74, v74, v11
    s_waitcnt vmcnt(5)
    buffer_load_dwordx4 v[196:199], v96, s[20:23], 0 offen offset:3456 nt
    v_perm_b32 v12, v75, v75, v4
    v_perm_b32 v13, v75, v75, v5
    v_mfma_f32_16x16x32_bf16 v[20:23], v[16:19], v[172:175], v[20:23]
    v_perm_b32 v14, v75, v75, v6
    v_perm_b32 v15, v75, v75, v7
    s_waitcnt vmcnt(5)
    buffer_load_dwordx4 v[200:203], v96, s[20:23], s16 offen offset:0 nt
    v_perm_b32 v16, v75, v75, v8
    v_perm_b32 v17, v75, v75, v9
    v_mfma_f32_16x16x32_bf16 v[20:23], v[12:15], v[176:179], v[20:23]
    v_perm_b32 v18, v75, v75, v10
    v_perm_b32 v19, v75, v75, v11
    s_waitcnt vmcnt(5)
    buffer_load_dwordx4 v[204:207], v96, s[20:23], s16 offen offset:1152 nt
    buffer_load_dwordx4 v[208:211], v96, s[20:23], s16 offen offset:2304 nt
    v_mfma_f32_16x16x32_bf16 v[20:23], v[16:19], v[180:183], v[20:23]
    s_nop 7
    v_mul_f32 v20, v20, v94
    v_mul_f32 v21, v21, v94
    v_mul_f32 v22, v22, v94
    v_mul_f32 v23, v23, v94
    ds_write_b128 v95, v[20:23] offset:1024
    s_waitcnt lgkmcnt(0)
    s_barrier
    s_barrier
    buffer_load_dwordx4 v[212:215], v96, s[20:23], s16 offen offset:3456 nt
    buffer_load_dwordx4 v[216:219], v96, s[20:23], s17 offen offset:0 nt
    buffer_load_dwordx4 v[220:223], v96, s[20:23], s17 offen offset:1152 nt
    buffer_load_dwordx4 v[224:227], v96, s[20:23], s17 offen offset:2304 nt
    buffer_load_dwordx4 v[228:231], v96, s[20:23], s17 offen offset:3456 nt
    buffer_load_dwordx4 v[232:235], v96, s[20:23], s18 offen offset:0 nt
    buffer_load_dwordx4 v[236:239], v96, s[20:23], s18 offen offset:1152 nt
    s_waitcnt vmcnt(13)
    buffer_load_dwordx4 v[240:243], v96, s[20:23], s18 offen offset:2304 nt
    s_waitcnt vmcnt(13)
    buffer_load_dwordx4 v[244:247], v96, s[20:23], s18 offen offset:3456 nt
    ds_read_b128 v[36:39], v99 offset:256
    ds_read_b128 v[40:43], v99 offset:272
    s_waitcnt lgkmcnt(0)
    v_perm_b32 v12, v36, v36, v4
    v_perm_b32 v13, v36, v36, v5
    v_perm_b32 v14, v36, v36, v6
    v_perm_b32 v15, v36, v36, v7
    v_perm_b32 v16, v36, v36, v8
    v_perm_b32 v17, v36, v36, v9
    v_mfma_f32_16x16x32_bf16 v[20:23], v[12:15], v[184:187], 0
    v_perm_b32 v18, v36, v36, v10
    v_perm_b32 v19, v36, v36, v11
    v_perm_b32 v12, v37, v37, v4
    v_perm_b32 v13, v37, v37, v5
    v_mfma_f32_16x16x32_bf16 v[20:23], v[16:19], v[188:191], v[20:23]
    v_perm_b32 v14, v37, v37, v6
    v_perm_b32 v15, v37, v37, v7
    v_perm_b32 v16, v37, v37, v8
    v_perm_b32 v17, v37, v37, v9
    s_waitcnt vmcnt(13)
    v_mfma_f32_16x16x32_bf16 v[20:23], v[12:15], v[192:195], v[20:23]
    v_perm_b32 v18, v37, v37, v10
    v_perm_b32 v19, v37, v37, v11
    v_perm_b32 v12, v38, v38, v4
    v_perm_b32 v13, v38, v38, v5
    s_waitcnt vmcnt(12)
    v_mfma_f32_16x16x32_bf16 v[20:23], v[16:19], v[196:199], v[20:23]
    v_perm_b32 v14, v38, v38, v6
    v_perm_b32 v15, v38, v38, v7
    v_perm_b32 v16, v38, v38, v8
    v_perm_b32 v17, v38, v38, v9
    s_waitcnt vmcnt(11)
    v_mfma_f32_16x16x32_bf16 v[20:23], v[12:15], v[200:203], v[20:23]
    v_perm_b32 v18, v38, v38, v10
    v_perm_b32 v19, v38, v38, v11
    v_perm_b32 v12, v39, v39, v4
    v_perm_b32 v13, v39, v39, v5
    s_waitcnt vmcnt(10)
    v_mfma_f32_16x16x32_bf16 v[20:23], v[16:19], v[204:207], v[20:23]
    v_perm_b32 v14, v39, v39, v6
    v_perm_b32 v15, v39, v39, v7
    v_perm_b32 v16, v39, v39, v8
    v_perm_b32 v17, v39, v39, v9
    s_waitcnt vmcnt(9)
    v_mfma_f32_16x16x32_bf16 v[20:23], v[12:15], v[208:211], v[20:23]
    v_perm_b32 v18, v39, v39, v10
    v_perm_b32 v19, v39, v39, v11
    v_perm_b32 v12, v40, v40, v4
    v_perm_b32 v13, v40, v40, v5
    s_waitcnt vmcnt(8)
    v_mfma_f32_16x16x32_bf16 v[20:23], v[16:19], v[212:215], v[20:23]
    v_perm_b32 v14, v40, v40, v6
    v_perm_b32 v15, v40, v40, v7
    v_perm_b32 v16, v40, v40, v8
    v_perm_b32 v17, v40, v40, v9
    s_waitcnt vmcnt(7)
    v_mfma_f32_16x16x32_bf16 v[20:23], v[12:15], v[216:219], v[20:23]
    v_perm_b32 v18, v40, v40, v10
    v_perm_b32 v19, v40, v40, v11
    v_perm_b32 v12, v41, v41, v4
    v_perm_b32 v13, v41, v41, v5
    s_waitcnt vmcnt(6)
    v_mfma_f32_16x16x32_bf16 v[20:23], v[16:19], v[220:223], v[20:23]
    v_perm_b32 v14, v41, v41, v6
    v_perm_b32 v15, v41, v41, v7
    v_perm_b32 v16, v41, v41, v8
    v_perm_b32 v17, v41, v41, v9
    s_waitcnt vmcnt(5)
    v_mfma_f32_16x16x32_bf16 v[20:23], v[12:15], v[224:227], v[20:23]
    v_perm_b32 v18, v41, v41, v10
    v_perm_b32 v19, v41, v41, v11
    v_perm_b32 v12, v42, v42, v4
    v_perm_b32 v13, v42, v42, v5
    s_waitcnt vmcnt(4)
    v_mfma_f32_16x16x32_bf16 v[20:23], v[16:19], v[228:231], v[20:23]
    v_perm_b32 v14, v42, v42, v6
    v_perm_b32 v15, v42, v42, v7
    v_perm_b32 v16, v42, v42, v8
    v_perm_b32 v17, v42, v42, v9
    s_waitcnt vmcnt(3)
    v_mfma_f32_16x16x32_bf16 v[20:23], v[12:15], v[232:235], v[20:23]
    v_perm_b32 v18, v42, v42, v10
    v_perm_b32 v19, v42, v42, v11
    v_perm_b32 v12, v43, v43, v4
    v_perm_b32 v13, v43, v43, v5
    s_waitcnt vmcnt(2)
    v_mfma_f32_16x16x32_bf16 v[20:23], v[16:19], v[236:239], v[20:23]
    v_perm_b32 v14, v43, v43, v6
    v_perm_b32 v15, v43, v43, v7
    v_perm_b32 v16, v43, v43, v8
    v_perm_b32 v17, v43, v43, v9
    s_waitcnt vmcnt(1)
    v_mfma_f32_16x16x32_bf16 v[20:23], v[12:15], v[240:243], v[20:23]
    v_perm_b32 v18, v43, v43, v10
    v_perm_b32 v19, v43, v43, v11
    s_waitcnt vmcnt(0)
    s_nop 0
    v_mfma_f32_16x16x32_bf16 v[20:23], v[16:19], v[244:247], v[20:23]
    s_nop 7
    v_permlane32_swap_b32 v20, v76
    v_permlane32_swap_b32 v21, v77
    v_permlane32_swap_b32 v22, v78
    v_permlane32_swap_b32 v23, v79
    v_add_f32_dpp v20, v76, v20 row_ror:8 row_mask:0xf bank_mask:0xf
    v_add_f32_dpp v21, v77, v21 row_ror:8 row_mask:0xf bank_mask:0xf
    v_add_f32_dpp v22, v78, v22 row_ror:8 row_mask:0xf bank_mask:0xf
    v_add_f32_dpp v23, v79, v23 row_ror:8 row_mask:0xf bank_mask:0xf
    v_and_or_b32 v20, v20, v2, s36
    v_and_or_b32 v21, v21, v2, s37
    v_and_or_b32 v22, v22, v2, s38
    v_and_or_b32 v23, v23, v2, s39
    buffer_store_dwordx4 v[20:23], v98, s[24:27], s50 offen sc1
    s_endpgm
L_tail_wo:
    buffer_load_dwordx4 v[184:187], v96, s[20:23], 0 offen offset:0 nt
    buffer_load_dwordx4 v[188:191], v96, s[20:23], 0 offen offset:1152 nt
    buffer_load_dwordx4 v[192:195], v96, s[20:23], 0 offen offset:2304 nt
    buffer_load_dwordx4 v[196:199], v96, s[20:23], 0 offen offset:3456 nt
    s_waitcnt vmcnt(10)
    buffer_load_dwordx4 v[200:203], v96, s[20:23], s16 offen offset:0 nt
    v_perm_b32 v12, v73, v73, v4
    v_perm_b32 v13, v73, v73, v5
    v_mfma_f32_16x16x32_bf16 v[20:23], v[16:19], v[156:159], v[20:23]
    v_perm_b32 v14, v73, v73, v6
    v_perm_b32 v15, v73, v73, v7
    s_waitcnt vmcnt(10)
    buffer_load_dwordx4 v[204:207], v96, s[20:23], s16 offen offset:1152 nt
    buffer_load_dwordx4 v[208:211], v96, s[20:23], s16 offen offset:2304 nt
    v_perm_b32 v16, v73, v73, v8
    v_perm_b32 v17, v73, v73, v9
    v_mfma_f32_16x16x32_bf16 v[20:23], v[12:15], v[160:163], v[20:23]
    v_perm_b32 v18, v73, v73, v10
    v_perm_b32 v19, v73, v73, v11
    s_waitcnt vmcnt(11)
    buffer_load_dwordx4 v[212:215], v96, s[20:23], s16 offen offset:3456 nt
    v_perm_b32 v12, v74, v74, v4
    v_perm_b32 v13, v74, v74, v5
    v_mfma_f32_16x16x32_bf16 v[20:23], v[16:19], v[164:167], v[20:23]
    v_perm_b32 v14, v74, v74, v6
    v_perm_b32 v15, v74, v74, v7
    s_waitcnt vmcnt(11)
    buffer_load_dwordx4 v[216:219], v96, s[20:23], s17 offen offset:0 nt
    v_perm_b32 v16, v74, v74, v8
    v_perm_b32 v17, v74, v74, v9
    v_mfma_f32_16x16x32_bf16 v[20:23], v[12:15], v[168:171], v[20:23]
    v_perm_b32 v18, v74, v74, v10
    v_perm_b32 v19, v74, v74, v11
    s_waitcnt vmcnt(11)
    buffer_load_dwordx4 v[220:223], v96, s[20:23], s17 offen offset:1152 nt
    v_perm_b32 v12, v75, v75, v4
    v_perm_b32 v13, v75, v75, v5
    v_mfma_f32_16x16x32_bf16 v[20:23], v[16:19], v[172:175], v[20:23]
    v_perm_b32 v14, v75, v75, v6
    v_perm_b32 v15, v75, v75, v7
    s_waitcnt vmcnt(11)
    buffer_load_dwordx4 v[224:227], v96, s[20:23], s17 offen offset:2304 nt
    v_perm_b32 v16, v75, v75, v8
    v_perm_b32 v17, v75, v75, v9
    v_mfma_f32_16x16x32_bf16 v[20:23], v[12:15], v[176:179], v[20:23]
    v_perm_b32 v18, v75, v75, v10
    v_perm_b32 v19, v75, v75, v11
    s_waitcnt vmcnt(11)
    buffer_load_dwordx4 v[228:231], v96, s[20:23], s17 offen offset:3456 nt
    v_mfma_f32_16x16x32_bf16 v[20:23], v[16:19], v[180:183], v[20:23]
    s_nop 7
    v_mul_f32 v20, v20, v94
    v_mul_f32 v21, v21, v94
    v_mul_f32 v22, v22, v94
    v_mul_f32 v23, v23, v94
    ds_write_b128 v95, v[20:23] offset:1024
    s_waitcnt lgkmcnt(0)
    s_barrier
    s_barrier
    s_waitcnt vmcnt(11)
    buffer_load_dwordx4 v[232:235], v96, s[20:23], s18 offen offset:0 nt
    s_waitcnt vmcnt(11)
    buffer_load_dwordx4 v[236:239], v96, s[20:23], s18 offen offset:1152 nt
    s_waitcnt vmcnt(11)
    buffer_load_dwordx4 v[240:243], v96, s[20:23], s18 offen offset:2304 nt
    s_waitcnt vmcnt(11)
    buffer_load_dwordx4 v[244:247], v96, s[20:23], s18 offen offset:3456 nt
    v_perm_b32 v104, v188, v184, s88
    v_perm_b32 v112, v188, v184, s89
    v_perm_b32 v120, v189, v185, s88
    v_perm_b32 v128, v189, v185, s89
    v_perm_b32 v136, v190, v186, s88
    v_perm_b32 v144, v190, v186, s89
    v_perm_b32 v152, v191, v187, s88
    v_perm_b32 v160, v191, v187, s89
    v_perm_b32 v105, v196, v192, s88
    v_perm_b32 v113, v196, v192, s89
    v_perm_b32 v121, v197, v193, s88
    v_perm_b32 v129, v197, v193, s89
    v_perm_b32 v137, v198, v194, s88
    v_perm_b32 v145, v198, v194, s89
    v_perm_b32 v153, v199, v195, s88
    v_perm_b32 v161, v199, v195, s89
    s_waitcnt vmcnt(10)
    v_perm_b32 v106, v204, v200, s88
    v_perm_b32 v114, v204, v200, s89
    v_perm_b32 v122, v205, v201, s88
    v_perm_b32 v130, v205, v201, s89
    v_perm_b32 v138, v206, v202, s88
    v_perm_b32 v146, v206, v202, s89
    v_perm_b32 v154, v207, v203, s88
    v_perm_b32 v162, v207, v203, s89
    s_waitcnt vmcnt(8)
    v_perm_b32 v107, v212, v208, s88
    v_perm_b32 v115, v212, v208, s89
    v_perm_b32 v123, v213, v209, s88
    v_perm_b32 v131, v213, v209, s89
    v_perm_b32 v139, v214, v210, s88
    v_perm_b32 v147, v214, v210, s89
    v_perm_b32 v155, v215, v211, s88
    v_perm_b32 v163, v215, v211, s89
    s_waitcnt vmcnt(6)
    v_perm_b32 v108, v220, v216, s88
    v_perm_b32 v116, v220, v216, s89
    v_perm_b32 v124, v221, v217, s88
    v_perm_b32 v132, v221, v217, s89
    v_perm_b32 v140, v222, v218, s88
    v_perm_b32 v148, v222, v218, s89
    v_perm_b32 v156, v223, v219, s88
    v_perm_b32 v164, v223, v219, s89
    s_waitcnt vmcnt(4)
    v_perm_b32 v109, v228, v224, s88
    v_perm_b32 v117, v228, v224, s89
    v_perm_b32 v125, v229, v225, s88
    v_perm_b32 v133, v229, v225, s89
    v_perm_b32 v141, v230, v226, s88
    v_perm_b32 v149, v230, v226, s89
    v_perm_b32 v157, v231, v227, s88
    v_perm_b32 v165, v231, v227, s89
    buffer_load_dwordx4 v[24:27], v88, s[24:27], s51 offen sc1
    buffer_load_dwordx4 v[28:31], v88, s[24:27], s90 offen sc1
    s_waitcnt vmcnt(4)
    v_perm_b32 v110, v236, v232, s88
    v_perm_b32 v118, v236, v232, s89
    v_perm_b32 v126, v237, v233, s88
    v_perm_b32 v134, v237, v233, s89
    v_perm_b32 v142, v238, v234, s88
    v_perm_b32 v150, v238, v234, s89
    v_perm_b32 v158, v239, v235, s88
    v_perm_b32 v166, v239, v235, s89
    s_waitcnt vmcnt(2)
    v_perm_b32 v111, v244, v240, s88
    v_perm_b32 v119, v244, v240, s89
    v_perm_b32 v127, v245, v241, s88
    v_perm_b32 v135, v245, v241, s89
    v_perm_b32 v143, v246, v242, s88
    v_perm_b32 v151, v246, v242, s89
    v_perm_b32 v159, v247, v243, s88
    v_perm_b32 v167, v247, v243, s89
    s_mov_b32 s47, 0
    s_branch L_oa_wait
L_oa_again:
    buffer_load_dwordx4 v[24:27], v88, s[24:27], s51 offen sc1
    buffer_load_dwordx4 v[28:31], v88, s[24:27], s90 offen sc1
    s_add_u32 s47, s47, 1
    s_cmp_ge_u32 s47, 262144
    s_cbranch_scc1 L_oa_ok
L_oa_wait:
    s_waitcnt vmcnt(0)
    v_xor_b32 v24, s36, v24
    v_xor_b32 v25, s37, v25
    v_xor_b32 v26, s38, v26
    v_xor_b32 v27, s39, v27
    v_xor_b32 v28, s36, v28
    v_xor_b32 v29, s37, v29
    v_xor_b32 v30, s38, v30
    v_xor_b32 v31, s39, v31
    v_or3_b32 v76, v24, v25, v26
    v_or3_b32 v77, v28, v29, v30
    v_or3_b32 v76, v76, v27, v31
    v_or_b32 v76, v76, v77
    v_cmp_ne_u32_sdwa vcc, v76, v91 src0_sel:BYTE_0 src1_sel:DWORD
    v_pk_add_f32 v[24:25], v[24:25], v[28:29]
    v_pk_add_f32 v[26:27], v[26:27], v[30:31]
    s_mov_b64 exec, vcc
    s_cbranch_execnz L_oa_again
L_oa_ok:
    s_mov_b64 exec, -1
    v_permlane32_swap_b32 v24, v26
    v_permlane32_swap_b32 v25, v27
    v_pk_add_f32 v[24:25], v[24:25], v[26:27]
    s_nop 1
    v_permlane16_swap_b32 v24, v25
    v_add_f32 v24, v24, v25
    s_nop 1
    v_add_f32_dpp v24, v24, v24 row_ror:8 row_mask:0xf bank_mask:0xf
    v_cvt_pk_bf16_f32 v24, v24, v24
    ds_write_b16 v89, v24 offset:256
    s_waitcnt lgkmcnt(0)
    s_barrier
    ds_read_b128 v[12:15], v90 offset:256
    ds_read_b128 v[16:19], v90 offset:272
    s_waitcnt lgkmcnt(1)
    v_mfma_f32_16x16x32_bf16 v[44:47], v[12:15], v[104:107], 0
    s_waitcnt lgkmcnt(0)
    v_mfma_f32_16x16x32_bf16 v[48:51], v[12:15], v[112:115], 0
    v_mfma_f32_16x16x32_bf16 v[52:55], v[12:15], v[120:123], 0
    v_mfma_f32_16x16x32_bf16 v[56:59], v[12:15], v[128:131], 0
    v_mfma_f32_16x16x32_bf16 v[60:63], v[12:15], v[136:139], 0
    v_mfma_f32_16x16x32_bf16 v[64:67], v[12:15], v[144:147], 0
    v_mfma_f32_16x16x32_bf16 v[68:71], v[12:15], v[152:155], 0
    v_mfma_f32_16x16x32_bf16 v[72:75], v[12:15], v[160:163], 0
    v_mfma_f32_16x16x32_bf16 v[44:47], v[16:19], v[108:111], v[44:47]
    v_mfma_f32_16x16x32_bf16 v[60:63], v[16:19], v[140:143], v[60:63]
    v_mfma_f32_16x16x32_bf16 v[48:51], v[16:19], v[116:119], v[48:51]
    v_mfma_f32_16x16x32_bf16 v[64:67], v[16:19], v[148:151], v[64:67]
    v_mfma_f32_16x16x32_bf16 v[52:55], v[16:19], v[124:127], v[52:55]
    v_mfma_f32_16x16x32_bf16 v[68:71], v[16:19], v[156:159], v[68:71]
    v_mfma_f32_16x16x32_bf16 v[56:59], v[16:19], v[132:135], v[56:59]
    v_mfma_f32_16x16x32_bf16 v[72:75], v[16:19], v[164:167], v[72:75]
    s_nop 0
    v_add_f32_dpp v20, v45, v44 row_ror:8 row_mask:0x1 bank_mask:0xf
    s_nop 0
    v_add_f32_dpp v21, v49, v48 row_ror:8 row_mask:0x1 bank_mask:0xf
    s_nop 0
    v_add_f32_dpp v22, v53, v52 row_ror:8 row_mask:0x1 bank_mask:0xf
    v_add_f32_dpp v20, v61, v60 row_ror:8 row_mask:0x2 bank_mask:0xf
    v_add_f32_dpp v21, v65, v64 row_ror:8 row_mask:0x2 bank_mask:0xf
    v_add_f32_dpp v23, v57, v56 row_ror:8 row_mask:0x1 bank_mask:0xf
    v_add_f32_dpp v22, v69, v68 row_ror:8 row_mask:0x2 bank_mask:0xf
    v_and_or_b32 v20, v20, v2, s36
    v_and_or_b32 v21, v21, v2, s37
    v_add_f32_dpp v23, v73, v72 row_ror:8 row_mask:0x2 bank_mask:0xf
    v_and_or_b32 v22, v22, v2, s38
    v_and_or_b32 v23, v23, v2, s39
    buffer_store_dwordx4 v[20:23], v98, s[24:27], s50 offen sc1
    s_endpgm
L_helper:
    v_and_b32 v0, 63, v0
    v_lshlrev_b32 v1, 4, v0
    s_and_b32 s6, s5, 3
    s_lshr_b32 s7, s5, 2
    s_mul_i32 s43, s6, 288
    v_lshrrev_b32 v76, 3, v0
    v_mul_u32_u24 v76, 36, v76
    v_add_u32 v77, s43, v76
    v_lshlrev_b32 v79, 2, v0
    s_movk_i32 s30, 1152
    s_mov_b32 s31, 0x20000
    v_mov_b32 v94, 0
    s_waitcnt lgkmcnt(0)
    s_mov_b32 s28, s64
    s_mov_b32 s29, s65
    buffer_load_dwordx4 v[60:63], v1, s[28:31], 0 offen
    buffer_load_dword v64, v79, s[28:31], 0 offen offset:1024
    buffer_load_dwordx4 v[66:69], v77, s[28:31], 0 offen
    buffer_load_dwordx4 v[70:73], v77, s[28:31], 0 offen offset:16
    buffer_load_dword v74, v77, s[28:31], 0 offen offset:32
    s_load_dwordx8 s[80:87], s[0:1], 64
    ds_write2st64_b32 v79, v94, v94 offset1:1
    s_waitcnt lgkmcnt(0)
    s_load_dword s40, s[86:87], 0
    s_mov_b32 s24, s86
    s_mov_b32 s25, s87
    s_mov_b32 s26, 1507328
    s_mov_b32 s27, 0x20000
    s_lshl2_add_u32 s43, s4, s6
    s_lshl2_add_u32 s43, s43, s7
    s_lshl_b32 s43, s43, 8
    s_add_u32 s43, s43, 32768
    s_mov_b32 s50, s43
    s_add_u32 s96, s86, s43
    s_addc_u32 s97, s87, 0
    s_load_dword s92, s[96:97], 0
    s_load_dword s93, s[96:97], 64
    s_load_dword s94, s[96:97], 128
    s_load_dword s95, s[96:97], 192
    s_and_b32 s45, s2, 7
    s_lshl_b32 s45, s45, 12
    s_add_u32 s45, s45, 1146880
    s_lshr_b32 s43, s2, 3
    s_lshl_b32 s43, s43, 7
    s_add_u32 s43, s43, s45
    s_add_u32 s96, s86, s43
    s_addc_u32 s97, s87, 0
    s_load_dword s92, s[96:97], 0
    s_load_dword s93, s[96:97], 64
    s_and_b32 s43, s7, 1
    s_lshl2_add_u32 s43, s43, s6
    s_lshr_b32 s44, s4, 3
    s_lshl1_add_u32 s43, s43, s44
    s_mul_i32 s43, s43, 72
    s_and_b32 s44, s4, 7
    s_mul_i32 s44, s44, 9
    s_add_u32 s43, s43, s44
    s_lshr_b32 s44, s7, 1
    s_lshl2_add_u32 s43, s44, s43
    s_lshl_b32 s43, s43, 8
    s_add_u32 s43, s43, 1179648
    s_add_u32 s96, s86, s43
    s_addc_u32 s97, s87, 0
    s_load_dword s92, s[96:97], 0
    s_load_dword s93, s[96:97], 64
    s_load_dword s94, s[96:97], 128
    s_load_dword s95, s[96:97], 192
    s_load_dword s92, s[96:97], 256
    s_load_dword s93, s[96:97], 320
    s_load_dword s94, s[96:97], 384
    s_load_dword s95, s[96:97], 448
    s_load_dword s92, s[96:97], 512
    s_load_dword s93, s[96:97], 576
    s_load_dword s94, s[96:97], 640
    s_load_dword s95, s[96:97], 704
    s_load_dword s92, s[96:97], 768
    s_load_dword s93, s[96:97], 832
    s_load_dword s94, s[96:97], 896
    s_load_dword s95, s[96:97], 960
    s_load_dword s92, s[96:97], 1024
    s_load_dword s93, s[96:97], 1088
    s_load_dword s94, s[96:97], 1152
    s_load_dword s95, s[96:97], 1216
    s_lshl4_add_u32 s43, s4, s5
    s_lshl_b32 s43, s43, 7
    s_add_u32 s43, s43, 1114112
    s_add_u32 s96, s86, s43
    s_addc_u32 s97, s87, 0
    s_load_dword s92, s[96:97], 0
    s_load_dword s93, s[96:97], 64
    v_and_b32 v76, 1, v0
    v_cmp_eq_u32 vcc, 0, v76
    v_mov_b32 v77, 0x0c0c0100
    v_mov_b32 v78, 0x0c0c0302
    v_mov_b32 v79, 0x0c0c0c0c
    v_mov_b32 v4, 0x01000c0c
    v_mov_b32 v5, 0x03020c0c
    v_cndmask_b32 v77, v4, v77, vcc
    v_cndmask_b32 v78, v5, v78, vcc
    v_bfe_u32 v76, v0, 1, 2
    v_mov_b32 v2, 0xffffff00
    v_cmp_eq_u32 vcc, 0, v76
    s_nop 1
    v_cndmask_b32 v4, v79, v77, vcc
    v_cndmask_b32 v8, v79, v78, vcc
    v_cmp_eq_u32 vcc, 1, v76
    s_nop 1
    v_cndmask_b32 v5, v79, v77, vcc
    v_cndmask_b32 v9, v79, v78, vcc
    v_cmp_eq_u32 vcc, 2, v76
    s_nop 1
    v_cndmask_b32 v6, v79, v77, vcc
    v_cndmask_b32 v10, v79, v78, vcc
    v_cmp_eq_u32 vcc, 3, v76
    s_nop 1
    v_cndmask_b32 v7, v79, v77, vcc
    v_cndmask_b32 v11, v79, v78, vcc
    v_lshrrev_b32 v76, 5, v0
    v_bfe_u32 v77, v0, 3, 1
    v_lshl_or_b32 v76, v77, 1, v76
    v_bfe_u32 v77, v0, 2, 1
    v_lshl_or_b32 v77, v76, 1, v77
    v_cmp_gt_u32 vcc, 1, v76
    v_and_b32 v76, 3, v0
    v_lshlrev_b32 v76, 5, v76
    v_and_or_b32 v76, v0, 16, v76
    v_lshl_or_b32 v76, v77, 7, v76
    v_mov_b32 v77, 2146435072
    v_cndmask_b32 v98, v77, v76, vcc
    v_lshrrev_b32 v76, 5, v0
    v_bfe_u32 v77, v0, 3, 1
    v_lshl_or_b32 v76, v77, 1, v76
    v_bfe_u32 v77, v0, 2, 1
    v_lshl_or_b32 v77, v76, 1, v77
    v_cmp_gt_u32 vcc, 4, v76
    v_and_b32 v76, 3, v0
    v_lshlrev_b32 v76, 5, v76
    v_and_or_b32 v76, v0, 16, v76
    v_lshl_or_b32 v76, v77, 7, v76
    v_mov_b32 v77, 2146435072
    v_cndmask_b32 v95, v77, v76, vcc
    s_waitcnt vmcnt(0)
    v_lshlrev_b32 v44, 16, v60
    v_and_b32 v45, 0xffff0000, v60
    v_lshlrev_b32 v46, 16, v61
    v_and_b32 v47, 0xffff0000, v61
    v_lshlrev_b32 v48, 16, v62
    v_and_b32 v49, 0xffff0000, v62
    v_lshlrev_b32 v50, 16, v63
    v_and_b32 v51, 0xffff0000, v63
    v_lshlrev_b32 v52, 16, v64
    v_and_b32 v53, 0xffff0000, v64
    v_add_f32 v54, v44, v45
    v_add_f32 v55, v46, v47
    v_add_f32 v56, v48, v49
    v_add_f32 v57, v50, v51
    v_add_f32 v54, v54, v55
    v_add_f32 v56, v56, v57
    v_add_f32 v55, v52, v53
    v_add_f32 v54, v54, v56
    v_add_f32 v54, v54, v55
    s_nop 1
    v_add_f32_dpp v54, v54, v54 row_ror:8 row_mask:0xf bank_mask:0xf
    s_nop 1
    v_add_f32_dpp v54, v54, v54 row_ror:4 row_mask:0xf bank_mask:0xf
    s_nop 1
    v_add_f32_dpp v54, v54, v54 row_ror:2 row_mask:0xf bank_mask:0xf
    s_nop 1
    v_add_f32_dpp v54, v54, v54 row_ror:1 row_mask:0xf bank_mask:0xf
    v_mov_b32 v55, v54
    s_nop 1
    v_permlane16_swap_b32 v54, v55
    v_add_f32 v54, v54, v55
    v_mov_b32 v55, v54
    s_nop 1
    v_permlane32_swap_b32 v54, v55
    v_add_f32 v54, v54, v55
    v_mul_f32 v54, 0x3ae38e39, v54
    v_cmp_gt_u32 vcc, 32, v0
    v_sub_f32 v44, v44, v54
    v_sub_f32 v45, v45, v54
    v_sub_f32 v46, v46, v54
    v_sub_f32 v47, v47, v54
    v_sub_f32 v48, v48, v54
    v_sub_f32 v49, v49, v54
    v_sub_f32 v50, v50, v54
    v_sub_f32 v51, v51, v54
    v_sub_f32 v52, v52, v54
    v_sub_f32 v53, v53, v54
    v_cndmask_b32 v52, 0, v52, vcc
    v_cndmask_b32 v53, 0, v53, vcc
    v_mul_f32 v56, v44, v44
    v_mul_f32 v57, v45, v45
    v_fmac_f32 v56, v46, v46
    v_fmac_f32 v57, v47, v47
    v_fmac_f32 v56, v48, v48
    v_fmac_f32 v57, v49, v49
    v_fmac_f32 v56, v50, v50
    v_fmac_f32 v57, v51, v51
    v_fmac_f32 v56, v52, v52
    v_fmac_f32 v57, v53, v53
    v_add_f32 v56, v56, v57
    s_nop 1
    v_add_f32_dpp v56, v56, v56 row_ror:8 row_mask:0xf bank_mask:0xf
    s_nop 1
    v_add_f32_dpp v56, v56, v56 row_ror:4 row_mask:0xf bank_mask:0xf
    s_nop 1
    v_add_f32_dpp v56, v56, v56 row_ror:2 row_mask:0xf bank_mask:0xf
    s_nop 1
    v_add_f32_dpp v56, v56, v56 row_ror:1 row_mask:0xf bank_mask:0xf
    v_mov_b32 v55, v56
    s_nop 1
    v_permlane16_swap_b32 v56, v55
    v_add_f32 v56, v56, v55
    v_mov_b32 v55, v56
    s_nop 1
    v_permlane32_swap_b32 v56, v55
    v_add_f32 v56, v56, v55
    v_mul_f32 v56, 0x3ae38e39, v56
    v_cvt_pk_bf16_f32 v56, v56, v56
    v_and_b32 v56, 0xffff0000, v56
    v_cvt_pk_bf16_f32 v54, v54, v54
    v_and_b32 v54, 0xffff0000, v54
    v_add_f32 v56, 0x3727c5ac, v56
    v_cvt_pk_bf16_f32 v56, v56, v56
    v_and_b32 v56, 0xffff0000, v56
    v_sqrt_f32 v56, v56
    s_nop 0
    v_cvt_pk_bf16_f32 v56, v56, v56
    v_and_b32 v56, 0xffff0000, v56
    v_rcp_f32 v57, v56
    v_lshlrev_b32 v44, 16, v66
    v_and_b32 v45, 0xffff0000, v66
    v_sub_f32 v44, v44, v54
    v_sub_f32 v45, v45, v54
    v_cvt_pk_bf16_f32 v45, v44, v45
    v_lshlrev_b32 v44, 16, v45
    v_and_b32 v45, 0xffff0000, v45
    v_mul_f32 v46, v44, v57
    v_mul_f32 v47, v45, v57
    v_fma_f32 v44, -v46, v56, v44
    v_fma_f32 v45, -v47, v56, v45
    v_fmac_f32 v46, v44, v57
    v_fmac_f32 v47, v45, v57
    v_cvt_pk_bf16_f32 v36, v46, v47
    v_lshlrev_b32 v44, 16, v67
    v_and_b32 v45, 0xffff0000, v67
    v_sub_f32 v44, v44, v54
    v_sub_f32 v45, v45, v54
    v_cvt_pk_bf16_f32 v45, v44, v45
    v_lshlrev_b32 v44, 16, v45
    v_and_b32 v45, 0xffff0000, v45
    v_mul_f32 v46, v44, v57
    v_mul_f32 v47, v45, v57
    v_fma_f32 v44, -v46, v56, v44
    v_fma_f32 v45, -v47, v56, v45
    v_fmac_f32 v46, v44, v57
    v_fmac_f32 v47, v45, v57
    v_cvt_pk_bf16_f32 v37, v46, v47
    v_lshlrev_b32 v44, 16, v68
    v_and_b32 v45, 0xffff0000, v68
    v_sub_f32 v44, v44, v54
    v_sub_f32 v45, v45, v54
    v_cvt_pk_bf16_f32 v45, v44, v45
    v_lshlrev_b32 v44, 16, v45
    v_and_b32 v45, 0xffff0000, v45
    v_mul_f32 v46, v44, v57
    v_mul_f32 v47, v45, v57
    v_fma_f32 v44, -v46, v56, v44
    v_fma_f32 v45, -v47, v56, v45
    v_fmac_f32 v46, v44, v57
    v_fmac_f32 v47, v45, v57
    v_cvt_pk_bf16_f32 v38, v46, v47
    v_lshlrev_b32 v44, 16, v69
    v_and_b32 v45, 0xffff0000, v69
    v_sub_f32 v44, v44, v54
    v_sub_f32 v45, v45, v54
    v_cvt_pk_bf16_f32 v45, v44, v45
    v_lshlrev_b32 v44, 16, v45
    v_and_b32 v45, 0xffff0000, v45
    v_mul_f32 v46, v44, v57
    v_mul_f32 v47, v45, v57
    v_fma_f32 v44, -v46, v56, v44
    v_fma_f32 v45, -v47, v56, v45
    v_fmac_f32 v46, v44, v57
    v_fmac_f32 v47, v45, v57
    v_cvt_pk_bf16_f32 v39, v46, v47
    v_lshlrev_b32 v44, 16, v70
    v_and_b32 v45, 0xffff0000, v70
    v_sub_f32 v44, v44, v54
    v_sub_f32 v45, v45, v54
    v_cvt_pk_bf16_f32 v45, v44, v45
    v_lshlrev_b32 v44, 16, v45
    v_and_b32 v45, 0xffff0000, v45
    v_mul_f32 v46, v44, v57
    v_mul_f32 v47, v45, v57
    v_fma_f32 v44, -v46, v56, v44
    v_fma_f32 v45, -v47, v56, v45
    v_fmac_f32 v46, v44, v57
    v_fmac_f32 v47, v45, v57
    v_cvt_pk_bf16_f32 v40, v46, v47
    v_lshlrev_b32 v44, 16, v71
    v_and_b32 v45, 0xffff0000, v71
    v_sub_f32 v44, v44, v54
    v_sub_f32 v45, v45, v54
    v_cvt_pk_bf16_f32 v45, v44, v45
    v_lshlrev_b32 v44, 16, v45
    v_and_b32 v45, 0xffff0000, v45
    v_mul_f32 v46, v44, v57
    v_mul_f32 v47, v45, v57
    v_fma_f32 v44, -v46, v56, v44
    v_fma_f32 v45, -v47, v56, v45
    v_fmac_f32 v46, v44, v57
    v_fmac_f32 v47, v45, v57
    v_cvt_pk_bf16_f32 v41, v46, v47
    v_lshlrev_b32 v44, 16, v72
    v_and_b32 v45, 0xffff0000, v72
    v_sub_f32 v44, v44, v54
    v_sub_f32 v45, v45, v54
    v_cvt_pk_bf16_f32 v45, v44, v45
    v_lshlrev_b32 v44, 16, v45
    v_and_b32 v45, 0xffff0000, v45
    v_mul_f32 v46, v44, v57
    v_mul_f32 v47, v45, v57
    v_fma_f32 v44, -v46, v56, v44
    v_fma_f32 v45, -v47, v56, v45
    v_fmac_f32 v46, v44, v57
    v_fmac_f32 v47, v45, v57
    v_cvt_pk_bf16_f32 v42, v46, v47
    v_lshlrev_b32 v44, 16, v73
    v_and_b32 v45, 0xffff0000, v73
    v_sub_f32 v44, v44, v54
    v_sub_f32 v45, v45, v54
    v_cvt_pk_bf16_f32 v45, v44, v45
    v_lshlrev_b32 v44, 16, v45
    v_and_b32 v45, 0xffff0000, v45
    v_mul_f32 v46, v44, v57
    v_mul_f32 v47, v45, v57
    v_fma_f32 v44, -v46, v56, v44
    v_fma_f32 v45, -v47, v56, v45
    v_fmac_f32 v46, v44, v57
    v_fmac_f32 v47, v45, v57
    v_cvt_pk_bf16_f32 v43, v46, v47
    v_lshlrev_b32 v44, 16, v74
    v_and_b32 v45, 0xffff0000, v74
    v_sub_f32 v44, v44, v54
    v_sub_f32 v45, v45, v54
    v_cvt_pk_bf16_f32 v45, v44, v45
    v_lshlrev_b32 v44, 16, v45
    v_and_b32 v45, 0xffff0000, v45
    v_mul_f32 v46, v44, v57
    v_mul_f32 v47, v45, v57
    v_fma_f32 v44, -v46, v56, v44
    v_fma_f32 v45, -v47, v56, v45
    v_fmac_f32 v46, v44, v57
    v_fmac_f32 v47, v45, v57
    v_cvt_pk_bf16_f32 v91, v46, v47
    v_mov_b32 v100, 0xffffffe0
    v_and_b32 v99, 15, v0
    v_lshlrev_b32 v99, 8, v99
    v_and_or_b32 v99, v0, 48, v99
    v_perm_b32 v12, v36, v36, v4
    v_perm_b32 v13, v36, v36, v5
    v_perm_b32 v14, v36, v36, v6
    v_perm_b32 v15, v36, v36, v7
    v_lshrrev_b32 v76, 4, v0
    v_bfe_u32 v77, v0, 3, 1
    v_mul_u32_u24 v76, 5120, v76
    v_mul_u32_u24 v77, 2304, v77
    v_and_b32 v78, 0x70, v1
    v_add3_u32 v96, v76, v77, v78
    v_add_u32 v96, 57344, v96
    s_barrier
    s_waitcnt lgkmcnt(0)
    ds_read_b128 v[104:107], v96 offset:0
    ds_read_b128 v[108:111], v96 offset:128
    ds_read_b128 v[112:115], v96 offset:256
    ds_read_b128 v[116:119], v96 offset:384
    ds_read_b128 v[120:123], v96 offset:512
    ds_read_b128 v[124:127], v96 offset:640
    ds_read_b128 v[128:131], v96 offset:768
    ds_read_b128 v[132:135], v96 offset:896
    ds_read_b128 v[136:139], v96 offset:1024
    ds_read_b128 v[140:143], v96 offset:1152
    ds_read_b128 v[144:147], v96 offset:1280
    ds_read_b128 v[148:151], v96 offset:1408
    s_add_u32 s48, s40, 0x2b573b1d
    s_and_b32 s36, s48, 0xff
    s_bfe_u32 s37, s48, 0x80008
    s_bfe_u32 s38, s48, 0x80010
    s_lshr_b32 s39, s48, 24
    s_getreg_b32 s43, hwreg(HW_REG_XCC_ID, 0, 4)
    s_and_b32 s88, s36, 15
    s_bfe_u32 s44, s43, 65536
    s_lshl_b32 s44, s44, 4
    s_or_b32 s88, s88, s44
    s_and_b32 s89, s37, 15
    s_bfe_u32 s44, s43, 65537
    s_lshl_b32 s44, s44, 4
    s_or_b32 s89, s89, s44
    s_and_b32 s90, s38, 15
    s_bfe_u32 s44, s43, 65538
    s_lshl_b32 s44, s44, 4
    s_or_b32 s90, s90, s44
    s_and_b32 s91, s39, 15
    s_bfe_u32 s44, s43, 65539
    s_lshl_b32 s44, s44, 4
    s_or_b32 s91, s91, s44
    ds_read_b128 v[152:155], v96 offset:1536
    v_perm_b32 v16, v36, v36, v8
    v_perm_b32 v17, v36, v36, v9
    s_waitcnt lgkmcnt(12)
    v_mfma_f32_16x16x32_bf16 v[20:23], v[12:15], v[104:107], 0
    v_perm_b32 v18, v36, v36, v10
    v_perm_b32 v19, v36, v36, v11
    ds_read_b128 v[156:159], v96 offset:1664
    v_perm_b32 v12, v37, v37, v4
    v_perm_b32 v13, v37, v37, v5
    s_waitcnt lgkmcnt(12)
    v_mfma_f32_16x16x32_bf16 v[20:23], v[16:19], v[108:111], v[20:23]
    v_perm_b32 v14, v37, v37, v6
    v_perm_b32 v15, v37, v37, v7
    ds_read_b128 v[160:163], v96 offset:1792
    v_perm_b32 v16, v37, v37, v8
    v_perm_b32 v17, v37, v37, v9
    s_waitcnt lgkmcnt(12)
    v_mfma_f32_16x16x32_bf16 v[20:23], v[12:15], v[112:115], v[20:23]
    v_perm_b32 v18, v37, v37, v10
    v_perm_b32 v19, v37, v37, v11
    ds_read_b128 v[164:167], v96 offset:1920
    v_perm_b32 v12, v38, v38, v4
    v_perm_b32 v13, v38, v38, v5
    s_waitcnt lgkmcnt(12)
    v_mfma_f32_16x16x32_bf16 v[20:23], v[16:19], v[116:119], v[20:23]
    v_perm_b32 v14, v38, v38, v6
    v_perm_b32 v15, v38, v38, v7
    ds_read_b128 v[168:171], v96 offset:2048
    v_perm_b32 v16, v38, v38, v8
    v_perm_b32 v17, v38, v38, v9
    s_waitcnt lgkmcnt(12)
    v_mfma_f32_16x16x32_bf16 v[20:23], v[12:15], v[120:123], v[20:23]
    v_perm_b32 v18, v38, v38, v10
    v_perm_b32 v19, v38, v38, v11
    ds_read_b128 v[172:175], v96 offset:2176
    v_perm_b32 v12, v39, v39, v4
    v_perm_b32 v13, v39, v39, v5
    s_waitcnt lgkmcnt(12)
    v_mfma_f32_16x16x32_bf16 v[20:23], v[16:19], v[124:127], v[20:23]
    v_perm_b32 v14, v39, v39, v6
    v_perm_b32 v15, v39, v39, v7
    v_perm_b32 v16, v39, v39, v8
    v_perm_b32 v17, v39, v39, v9
    s_waitcnt lgkmcnt(11)
    v_mfma_f32_16x16x32_bf16 v[20:23], v[12:15], v[128:131], v[20:23]
    v_perm_b32 v18, v39, v39, v10
    v_perm_b32 v19, v39, v39, v11
    v_perm_b32 v12, v40, v40, v4
    v_perm_b32 v13, v40, v40, v5
    s_waitcnt lgkmcnt(10)
    v_mfma_f32_16x16x32_bf16 v[20:23], v[16:19], v[132:135], v[20:23]
    v_perm_b32 v14, v40, v40, v6
    v_perm_b32 v15, v40, v40, v7
    v_perm_b32 v16, v40, v40, v8
    v_perm_b32 v17, v40, v40, v9
    s_waitcnt lgkmcnt(9)
    v_mfma_f32_16x16x32_bf16 v[20:23], v[12:15], v[136:139], v[20:23]
    v_perm_b32 v18, v40, v40, v10
    v_perm_b32 v19, v40, v40, v11
    v_perm_b32 v12, v41, v41, v4
    v_perm_b32 v13, v41, v41, v5
    s_waitcnt lgkmcnt(8)
    v_mfma_f32_16x16x32_bf16 v[20:23], v[16:19], v[140:143], v[20:23]
    v_perm_b32 v14, v41, v41, v6
    v_perm_b32 v15, v41, v41, v7
    v_perm_b32 v16, v41, v41, v8
    v_perm_b32 v17, v41, v41, v9
    s_waitcnt lgkmcnt(7)
    v_mfma_f32_16x16x32_bf16 v[20:23], v[12:15], v[144:147], v[20:23]
    v_perm_b32 v18, v41, v41, v10
    v_perm_b32 v19, v41, v41, v11
    v_perm_b32 v12, v42, v42, v4
    v_perm_b32 v13, v42, v42, v5
    s_waitcnt lgkmcnt(6)
    v_mfma_f32_16x16x32_bf16 v[20:23], v[16:19], v[148:151], v[20:23]
    v_perm_b32 v14, v42, v42, v6
    v_perm_b32 v15, v42, v42, v7
    v_perm_b32 v16, v42, v42, v8
    v_perm_b32 v17, v42, v42, v9
    s_waitcnt lgkmcnt(5)
    v_mfma_f32_16x16x32_bf16 v[20:23], v[12:15], v[152:155], v[20:23]
    v_perm_b32 v18, v42, v42, v10
    v_perm_b32 v19, v42, v42, v11
    v_perm_b32 v12, v43, v43, v4
    v_perm_b32 v13, v43, v43, v5
    s_waitcnt lgkmcnt(4)
    v_mfma_f32_16x16x32_bf16 v[20:23], v[16:19], v[156:159], v[20:23]
    v_perm_b32 v14, v43, v43, v6
    v_perm_b32 v15, v43, v43, v7
    v_perm_b32 v16, v43, v43, v8
    v_perm_b32 v17, v43, v43, v9
    s_waitcnt lgkmcnt(3)
    v_mfma_f32_16x16x32_bf16 v[20:23], v[12:15], v[160:163], v[20:23]
    v_perm_b32 v18, v43, v43, v10
    v_perm_b32 v19, v43, v43, v11
    v_perm_b32 v12, v91, v91, v4
    v_perm_b32 v13, v91, v91, v5
    s_waitcnt lgkmcnt(2)
    v_mfma_f32_16x16x32_bf16 v[20:23], v[16:19], v[164:167], v[20:23]
    v_perm_b32 v14, v91, v91, v6
    v_perm_b32 v15, v91, v91, v7
    v_perm_b32 v16, v91, v91, v8
    v_perm_b32 v17, v91, v91, v9
    s_waitcnt lgkmcnt(1)
    v_mfma_f32_16x16x32_bf16 v[20:23], v[12:15], v[168:171], v[20:23]
    v_perm_b32 v18, v91, v91, v10
    v_perm_b32 v19, v91, v91, v11
    s_waitcnt lgkmcnt(0)
    s_nop 0
    v_mfma_f32_16x16x32_bf16 v[20:23], v[16:19], v[172:175], v[20:23]
    s_lshl_b32 s51, s4, 12
    s_xor_b32 s99, s51, 0x8000
    s_add_u32 s51, s51, 32768
    s_add_u32 s99, s99, 32768
    s_nop 3
    v_permlane32_swap_b32 v20, v76
    v_permlane32_swap_b32 v21, v77
    v_permlane32_swap_b32 v22, v78
    v_permlane32_swap_b32 v23, v79
    v_add_f32_dpp v20, v76, v20 row_ror:8 row_mask:0xf bank_mask:0xf
    v_add_f32_dpp v21, v77, v21 row_ror:8 row_mask:0xf bank_mask:0xf
    v_add_f32_dpp v22, v78, v22 row_ror:8 row_mask:0xf bank_mask:0xf
    v_add_f32_dpp v23, v79, v23 row_ror:8 row_mask:0xf bank_mask:0xf
    v_and_or_b32 v20, v20, v100, s88
    v_and_or_b32 v21, v21, v100, s89
    v_and_or_b32 v22, v22, v100, s90
    v_and_or_b32 v23, v23, v100, s91
    buffer_store_dwordx4 v[20:23], v98, s[24:27], s50 offen
    v_lshrrev_b32 v76, 3, v0
    v_and_b32 v77, 0x70, v1
    v_mul_u32_u24 v97, 4608, v76
    v_add_u32 v97, v97, v77
    v_lshrrev_b32 v78, 1, v76
    v_and_b32 v76, 1, v76
    v_mul_u32_u24 v78, 3072, v78
    v_mul_u32_u24 v76, 1152, v76
    v_add3_u32 v96, v78, v76, v77
    s_waitcnt vmcnt(0)
    buffer_load_dwordx4 v[60:63], v1, s[24:27], s51 offen offset:0 sc1
    buffer_load_dwordx4 v[64:67], v1, s[24:27], s51 offen offset:1024 sc1
    buffer_load_dwordx4 v[68:71], v1, s[24:27], s51 offen offset:2048 sc1
    buffer_load_dwordx4 v[72:75], v1, s[24:27], s51 offen offset:3072 sc1
    buffer_load_dwordx4 v[44:47], v99, s[24:27], s99 offen sc1
    s_waitcnt vmcnt(0)
    s_mov_b32 s47, 0
L_q_chk:
    v_xor_b32 v60, s88, v60
    v_xor_b32 v61, s89, v61
    v_xor_b32 v62, s90, v62
    v_xor_b32 v63, s91, v63
    v_xor_b32 v64, s88, v64
    v_xor_b32 v65, s89, v65
    v_xor_b32 v66, s90, v66
    v_xor_b32 v67, s91, v67
    v_xor_b32 v68, s88, v68
    v_xor_b32 v69, s89, v69
    v_xor_b32 v70, s90, v70
    v_xor_b32 v71, s91, v71
    v_xor_b32 v72, s88, v72
    v_xor_b32 v73, s89, v73
    v_xor_b32 v74, s90, v74
    v_xor_b32 v75, s91, v75
    v_xor_b32 v44, s88, v44
    v_xor_b32 v45, s89, v45
    v_xor_b32 v46, s90, v46
    v_xor_b32 v47, s91, v47
    v_or3_b32 v84, v60, v61, v62
    v_or3_b32 v84, v84, v63, v64
    v_or3_b32 v84, v84, v65, v66
    v_or3_b32 v84, v84, v67, v68
    v_or3_b32 v84, v84, v69, v70
    v_or3_b32 v84, v84, v71, v72
    v_or3_b32 v84, v84, v73, v74
    v_or3_b32 v84, v84, v75, v44
    v_or3_b32 v84, v84, v45, v46
    v_or_b32 v84, v84, v47
    v_and_b32 v85, 16, v84
    v_and_b32 v84, 15, v84
    v_cmp_ne_u32 vcc, 0, v84
    s_cbranch_vccnz L_q_retry
L_q_ok:
    v_cmp_ne_u32 vcc, 0, v85
    v_and_b32 v60, v100, v60
    v_and_b32 v61, v100, v61
    v_and_b32 v62, v100, v62
    v_and_b32 v63, v100, v63
    v_and_b32 v64, v100, v64
    v_and_b32 v65, v100, v65
    v_and_b32 v66, v100, v66
    v_and_b32 v67, v100, v67
    v_and_b32 v68, v100, v68
    v_and_b32 v69, v100, v69
    v_and_b32 v70, v100, v70
    v_and_b32 v71, v100, v71
    v_and_b32 v72, v100, v72
    v_and_b32 v73, v100, v73
    v_and_b32 v74, v100, v74
    v_and_b32 v75, v100, v75
    s_or_b32 s98, vcc_lo, vcc_hi
    v_pk_add_f32 v[60:61], v[60:61], v[64:65]
    v_pk_add_f32 v[62:63], v[62:63], v[66:67]
    v_pk_add_f32 v[68:69], v[68:69], v[72:73]
    v_pk_add_f32 v[70:71], v[70:71], v[74:75]
    v_pk_add_f32 v[60:61], v[60:61], v[68:69]
    v_pk_add_f32 v[62:63], v[62:63], v[70:71]
    v_lshlrev_b32 v64, 3, v0
    v_cvt_pk_bf16_f32 v60, v60, v61
    v_cvt_pk_bf16_f32 v61, v62, v63
    ds_write_b64 v64, v[60:61] offset:512
    s_cmp_eq_u32 s98, 0
    s_cbranch_scc0 L_q_far
L_q_sd:
    v_mov_b32 v168, s36
    v_mov_b32 v169, s37
    v_mov_b32 v170, s38
    v_mov_b32 v171, s39
    s_and_b32 s45, s2, 7
    s_lshl_b32 s45, s45, 12
    s_add_u32 s45, s45, 1146880
    s_lshr_b32 s43, s2, 3
    s_lshl_b32 s43, s43, 7
    s_add_u32 s43, s43, s45
    v_lshlrev_b32 v176, 6, v0
    s_waitcnt lgkmcnt(0)
    s_barrier
    s_mov_b64 exec, 0xff
    buffer_store_dwordx4 v[168:171], v1, s[24:27], s43 offen
    s_mov_b64 exec, -1
    buffer_load_dwordx4 v[172:175], v176, s[24:27], s45 offen sc1
    s_bitcmp1_b32 s7, 0
    s_cselect_b64 vcc, -1, 0
    v_cndmask_b32 v4, v4, v8, vcc
    v_cndmask_b32 v5, v5, v9, vcc
    v_cndmask_b32 v6, v6, v10, vcc
    v_cndmask_b32 v7, v7, v11, vcc
    ds_read_b128 v[104:107], v97 offset:8192
    ds_read_b128 v[108:111], v97 offset:8320
    ds_read_b128 v[112:115], v97 offset:8448
    ds_read_b128 v[116:119], v97 offset:8576
    ds_read_b128 v[120:123], v96 offset:45056
    ds_read_b128 v[124:127], v97 offset:8704
    ds_read_b128 v[128:131], v97 offset:8832
    ds_read_b128 v[132:135], v97 offset:8960
    ds_read_b128 v[136:139], v97 offset:9088
    ds_read_b128 v[140:143], v96 offset:45184
    v_perm_b32 v12, v36, v36, v4
    v_perm_b32 v13, v36, v36, v5
    v_perm_b32 v14, v36, v36, v6
    v_perm_b32 v15, v36, v36, v7
    ds_read_b128 v[144:147], v97 offset:9216
    ds_read_b128 v[148:151], v97 offset:9344
    ds_read_b128 v[152:155], v97 offset:9472
    ds_read_b128 v[156:159], v97 offset:9600
    ds_read_b128 v[160:163], v96 offset:45312
    s_waitcnt lgkmcnt(10)
    v_mfma_f32_16x16x32_bf16 v[24:27], v[12:15], v[104:107], 0
    v_perm_b32 v16, v37, v37, v4
    v_mfma_f32_16x16x32_bf16 v[28:31], v[12:15], v[108:111], 0
    v_perm_b32 v17, v37, v37, v5
    v_mfma_f32_16x16x32_bf16 v[32:35], v[12:15], v[112:115], 0
    v_perm_b32 v18, v37, v37, v6
    v_mfma_f32_16x16x32_bf16 v[44:47], v[12:15], v[116:119], 0
    v_perm_b32 v19, v37, v37, v7
    v_mfma_f32_16x16x32_bf16 v[48:51], v[12:15], v[120:123], 0
    ds_read_b128 v[104:107], v97 offset:9728
    ds_read_b128 v[108:111], v97 offset:9856
    ds_read_b128 v[112:115], v97 offset:9984
    ds_read_b128 v[116:119], v97 offset:10112
    ds_read_b128 v[120:123], v96 offset:45440
    s_waitcnt lgkmcnt(10)
    v_mfma_f32_16x16x32_bf16 v[24:27], v[16:19], v[124:127], v[24:27]
    v_perm_b32 v12, v38, v38, v4
    v_mfma_f32_16x16x32_bf16 v[28:31], v[16:19], v[128:131], v[28:31]
    v_perm_b32 v13, v38, v38, v5
    v_mfma_f32_16x16x32_bf16 v[32:35], v[16:19], v[132:135], v[32:35]
    v_perm_b32 v14, v38, v38, v6
    v_mfma_f32_16x16x32_bf16 v[44:47], v[16:19], v[136:139], v[44:47]
    v_perm_b32 v15, v38, v38, v7
    v_mfma_f32_16x16x32_bf16 v[48:51], v[16:19], v[140:143], v[48:51]
    ds_read_b128 v[124:127], v97 offset:10240
    ds_read_b128 v[128:131], v97 offset:10368
    ds_read_b128 v[132:135], v97 offset:10496
    ds_read_b128 v[136:139], v97 offset:10624
    ds_read_b128 v[140:143], v96 offset:45568
    s_waitcnt lgkmcnt(10)
    v_mfma_f32_16x16x32_bf16 v[24:27], v[12:15], v[144:147], v[24:27]
    v_perm_b32 v16, v39, v39, v4
    v_mfma_f32_16x16x32_bf16 v[28:31], v[12:15], v[148:151], v[28:31]
    v_perm_b32 v17, v39, v39, v5
    v_mfma_f32_16x16x32_bf16 v[32:35], v[12:15], v[152:155], v[32:35]
    v_perm_b32 v18, v39, v39, v6
    v_mfma_f32_16x16x32_bf16 v[44:47], v[12:15], v[156:159], v[44:47]
    v_perm_b32 v19, v39, v39, v7
    v_mfma_f32_16x16x32_bf16 v[48:51], v[12:15], v[160:163], v[48:51]
    ds_read_b128 v[144:147], v97 offset:10752
    ds_read_b128 v[148:151], v97 offset:10880
    ds_read_b128 v[152:155], v97 offset:11008
    ds_read_b128 v[156:159], v97 offset:11136
    ds_read_b128 v[160:163], v96 offset:45696
    s_waitcnt lgkmcnt(10)
    v_mfma_f32_16x16x32_bf16 v[24:27], v[16:19], v[104:107], v[24:27]
    v_perm_b32 v12, v40, v40, v4
    v_mfma_f32_16x16x32_bf16 v[28:31], v[16:19], v[108:111], v[28:31]
    v_perm_b32 v13, v40, v40, v5
    v_mfma_f32_16x16x32_bf16 v[32:35], v[16:19], v[112:115], v[32:35]
    v_perm_b32 v14, v40, v40, v6
    v_mfma_f32_16x16x32_bf16 v[44:47], v[16:19], v[116:119], v[44:47]
    v_perm_b32 v15, v40, v40, v7
    v_mfma_f32_16x16x32_bf16 v[48:51], v[16:19], v[120:123], v[48:51]
    ds_read_b128 v[104:107], v97 offset:11264
    ds_read_b128 v[108:111], v97 offset:11392
    ds_read_b128 v[112:115], v97 offset:11520
    ds_read_b128 v[116:119], v97 offset:11648
    ds_read_b128 v[120:123], v96 offset:45824
    s_waitcnt lgkmcnt(10)
    v_mfma_f32_16x16x32_bf16 v[24:27], v[12:15], v[124:127], v[24:27]
    v_perm_b32 v16, v41, v41, v4
    v_mfma_f32_16x16x32_bf16 v[28:31], v[12:15], v[128:131], v[28:31]
    v_perm_b32 v17, v41, v41, v5
    v_mfma_f32_16x16x32_bf16 v[32:35], v[12:15], v[132:135], v[32:35]
    v_perm_b32 v18, v41, v41, v6
    v_mfma_f32_16x16x32_bf16 v[44:47], v[12:15], v[136:139], v[44:47]
    v_perm_b32 v19, v41, v41, v7
    v_mfma_f32_16x16x32_bf16 v[48:51], v[12:15], v[140:143], v[48:51]
    ds_read_b128 v[124:127], v97 offset:11776
    ds_read_b128 v[128:131], v97 offset:11904
    ds_read_b128 v[132:135], v97 offset:12032
    ds_read_b128 v[136:139], v97 offset:12160
    ds_read_b128 v[140:143], v96 offset:45952
    s_waitcnt lgkmcnt(10)
    v_mfma_f32_16x16x32_bf16 v[24:27], v[16:19], v[144:147], v[24:27]
    v_perm_b32 v12, v42, v42, v4
    v_mfma_f32_16x16x32_bf16 v[28:31], v[16:19], v[148:151], v[28:31]
    v_perm_b32 v13, v42, v42, v5
    v_mfma_f32_16x16x32_bf16 v[32:35], v[16:19], v[152:155], v[32:35]
    v_perm_b32 v14, v42, v42, v6
    v_mfma_f32_16x16x32_bf16 v[44:47], v[16:19], v[156:159], v[44:47]
    v_perm_b32 v15, v42, v42, v7
    v_mfma_f32_16x16x32_bf16 v[48:51], v[16:19], v[160:163], v[48:51]
    ds_read_b128 v[144:147], v97 offset:12288
    ds_read_b128 v[148:151], v97 offset:12416
    ds_read_b128 v[152:155], v97 offset:12544
    ds_read_b128 v[156:159], v97 offset:12672
    ds_read_b128 v[160:163], v96 offset:46080
    s_waitcnt lgkmcnt(10)
    v_mfma_f32_16x16x32_bf16 v[24:27], v[12:15], v[104:107], v[24:27]
    v_perm_b32 v16, v43, v43, v4
    v_mfma_f32_16x16x32_bf16 v[28:31], v[12:15], v[108:111], v[28:31]
    v_perm_b32 v17, v43, v43, v5
    v_mfma_f32_16x16x32_bf16 v[32:35], v[12:15], v[112:115], v[32:35]
    v_perm_b32 v18, v43, v43, v6
    v_mfma_f32_16x16x32_bf16 v[44:47], v[12:15], v[116:119], v[44:47]
    v_perm_b32 v19, v43, v43, v7
    v_mfma_f32_16x16x32_bf16 v[48:51], v[12:15], v[120:123], v[48:51]
    s_waitcnt lgkmcnt(5)
    v_mfma_f32_16x16x32_bf16 v[24:27], v[16:19], v[124:127], v[24:27]
    v_perm_b32 v12, v91, v91, v4
    v_mfma_f32_16x16x32_bf16 v[28:31], v[16:19], v[128:131], v[28:31]
    v_perm_b32 v13, v91, v91, v5
    v_mfma_f32_16x16x32_bf16 v[32:35], v[16:19], v[132:135], v[32:35]
    v_perm_b32 v14, v91, v91, v6
    v_mfma_f32_16x16x32_bf16 v[44:47], v[16:19], v[136:139], v[44:47]
    v_perm_b32 v15, v91, v91, v7
    v_mfma_f32_16x16x32_bf16 v[48:51], v[16:19], v[140:143], v[48:51]
    s_waitcnt lgkmcnt(0)
    v_mfma_f32_16x16x32_bf16 v[24:27], v[12:15], v[144:147], v[24:27]
    v_mfma_f32_16x16x32_bf16 v[28:31], v[12:15], v[148:151], v[28:31]
    v_mfma_f32_16x16x32_bf16 v[32:35], v[12:15], v[152:155], v[32:35]
    v_mfma_f32_16x16x32_bf16 v[44:47], v[12:15], v[156:159], v[44:47]
    v_mfma_f32_16x16x32_bf16 v[48:51], v[12:15], v[160:163], v[48:51]
    s_waitcnt vmcnt(0)
    v_xor_b32 v172, s36, v172
    v_xor_b32 v173, s37, v173
    v_xor_b32 v174, s38, v174
    v_xor_b32 v175, s39, v175
    v_or3_b32 v84, v172, v173, v174
    v_or_b32 v84, v84, v175
    v_and_b32 v84, 0xff, v84
    v_cmp_ne_u32 vcc, 0, v84
    s_nop 0
    s_bcnt0_i32_b64 s43, vcc
    s_lshr_b32 s43, s43, 1
    s_mul_i32 s44, s43, 1
    s_add_u32 s44, s44, -27
    s_max_u32 s45, s43, 26
    s_mul_i32 s45, s45, 2
    s_add_u32 s44, s44, s45
    s_cmp_gt_u32 s43, 12
    s_cselect_b32 s44, s44, 0
    v_mov_b32 v86, s44
    ds_max_u32 v94, v86 offset:96
    s_and_b32 s43, s7, 1
    s_lshl2_add_u32 s43, s43, s6
    s_lshr_b32 s44, s4, 3
    s_lshl1_add_u32 s43, s43, s44
    s_mul_i32 s43, s43, 72
    s_and_b32 s44, s4, 7
    s_mul_i32 s44, s44, 9
    s_add_u32 s43, s43, s44
    s_lshr_b32 s44, s7, 1
    s_lshl2_add_u32 s43, s44, s43
    s_lshl_b32 s43, s43, 8
    s_add_u32 s43, s43, 1179648
    v_permlane32_swap_b32 v24, v28
    v_permlane32_swap_b32 v25, v29
    v_permlane32_swap_b32 v26, v30
    v_permlane32_swap_b32 v27, v31
    v_permlane32_swap_b32 v32, v44
    v_permlane32_swap_b32 v33, v45
    v_permlane32_swap_b32 v34, v46
    v_permlane32_swap_b32 v35, v47
    v_add_f32_dpp v24, v28, v24 row_ror:8 row_mask:0xf bank_mask:0xf
    v_add_f32_dpp v25, v29, v25 row_ror:8 row_mask:0xf bank_mask:0xf
    v_add_f32_dpp v26, v30, v26 row_ror:8 row_mask:0xf bank_mask:0xf
    v_add_f32_dpp v27, v31, v27 row_ror:8 row_mask:0xf bank_mask:0xf
    v_add_f32_dpp v24, v32, v44 row_ror:8 row_mask:0xf bank_mask:0xc
    v_add_f32_dpp v25, v33, v45 row_ror:8 row_mask:0xf bank_mask:0xc
    v_add_f32_dpp v26, v34, v46 row_ror:8 row_mask:0xf bank_mask:0xc
    v_add_f32_dpp v27, v35, v47 row_ror:8 row_mask:0xf bank_mask:0xc
    v_and_or_b32 v24, v24, v2, s36
    v_and_or_b32 v25, v25, v2, s37
    v_and_or_b32 v26, v26, v2, s38
    v_and_or_b32 v27, v27, v2, s39
    s_cmp_eq_u32 s98, 0
    s_cbranch_scc0 L_gu_far
    buffer_store_dwordx4 v[24:27], v95, s[24:27], s43 offen
L_gu_sd:
    s_cmp_eq_u32 s44, 0
    s_cbranch_scc1 L_no5
    v_permlane32_swap_b32 v48, v76
    v_permlane32_swap_b32 v49, v77
    v_permlane32_swap_b32 v50, v78
    v_permlane32_swap_b32 v51, v79
    v_add_f32_dpp v48, v76, v48 row_ror:8 row_mask:0xf bank_mask:0xf
    v_add_f32_dpp v49, v77, v49 row_ror:8 row_mask:0xf bank_mask:0xf
    v_add_f32_dpp v50, v78, v50 row_ror:8 row_mask:0xf bank_mask:0xf
    v_add_f32_dpp v51, v79, v51 row_ror:8 row_mask:0xf bank_mask:0xf
    v_and_or_b32 v48, v48, v2, s36
    v_and_or_b32 v49, v49, v2, s37
    v_and_or_b32 v50, v50, v2, s38
    v_and_or_b32 v51, v51, v2, s39
    s_cmp_eq_u32 s98, 0
    s_cbranch_scc0 L_g5_far
    buffer_store_dwordx4 v[48:51], v98, s[24:27], s43 offen offset:1024
L_g5_sd:
L_no5:
    v_and_b32 v76, 15, v0
    v_lshlrev_b32 v76, 5, v76
    v_and_or_b32 v76, v0, 16, v76
    v_lshrrev_b32 v77, 5, v0
    v_lshl_or_b32 v39, v77, 9, v76
    s_lshr_b32 s6, s2, 3
    s_mul_i32 s7, s6, 43
    s_lshr_b32 s7, s7, 7
    s_cmpk_eq_u32 s2, 255
    s_cbranch_scc0 L_norace
    s_add_u32 s96, s86, 1572864
    s_addc_u32 s97, s87, 0
    s_mov_b32 s45, 0
    s_mov_b32 s46, 0
    s_mov_b32 s47, 0
    s_waitcnt lgkmcnt(0)
L_race:
    s_load_dword s9, s[96:97], 8704
    s_load_dword s8, s[96:97], 512
    s_waitcnt lgkmcnt(1)
    s_getreg_b32 s43, hwreg(HW_REG_IB_STS, 8, 4)
    s_cmp_eq_u32 s43, 0
    s_addc_u32 s45, s45, 0
    s_waitcnt lgkmcnt(0)
    s_load_dword s9, s[96:97], 0
    s_load_dword s8, s[96:97], 8192
    s_waitcnt lgkmcnt(1)
    s_getreg_b32 s43, hwreg(HW_REG_IB_STS, 8, 4)
    s_cmp_eq_u32 s43, 0
    s_addc_u32 s46, s46, 0
    s_waitcnt lgkmcnt(0)
    ds_read_b32 v60, v94 offset:4
    s_add_u32 s96, s96, 17408
    s_addc_u32 s97, s97, 0
    s_add_u32 s47, s47, 1
    s_waitcnt lgkmcnt(0)
    v_cmp_ne_u32 vcc, 0, v60
    s_cbranch_vccnz L_raced
    s_cmp_lt_u32 s47, 4
    s_cbranch_scc1 L_race
L_raced:
    s_cmp_gt_u32 s45, s46
    s_cselect_b32 s43, 0x2000, 0
    s_or_b32 s43, s43, s36
    v_mov_b32 v60, s43
    v_mov_b32 v61, s37
    v_mov_b32 v62, s38
    v_mov_b32 v63, s39
    s_movk_i32 s43, 4096
    s_mov_b64 exec, 0xff
    buffer_store_dwordx4 v[60:63], v1, s[24:27], s43 offen sc1
    s_mov_b64 exec, -1
L_norace:
    v_and_b32 v64, 48, v1
    v_lshrrev_b32 v100, 2, v0
    v_lshl_or_b32 v100, v100, 7, v64
    s_lshl_b32 s51, s4, 11
    s_add_u32 s51, s51, 1114112
    s_lshl_b32 s43, s5, 7
    s_add_u32 s43, s43, s51
    v_and_b32 v99, 31, v0
    v_lshlrev_b32 v99, 6, v99
    v_lshrrev_b32 v76, 5, v0
    v_lshl_or_b32 v99, v76, 14, v99
    s_and_b32 s99, s4, 7
    s_lshl_b32 s99, s99, 11
    s_add_u32 s99, s99, 1114112
    ds_read_b128 v[60:63], v64 offset:0
    s_waitcnt lgkmcnt(0)
    s_mov_b32 s47, 0
L_mw_chk:
    v_min_u32 v84, v61, v63
    v_cmp_eq_u32 vcc, 0, v84
    s_cbranch_vccnz L_mw_retry
L_mw_ok:
    v_and_or_b32 v68, v60, v2, s36
    v_and_or_b32 v69, v61, v2, s37
    v_and_or_b32 v70, v62, v2, s38
    v_and_or_b32 v71, v63, v2, s39
    s_mov_b64 exec, 0xff
    s_cmp_eq_u32 s98, 0
    s_cbranch_scc0 L_mp_far
    buffer_store_dwordx4 v[68:71], v1, s[24:27], s43 offen
L_mp_sd:
    s_mov_b64 exec, -1
    buffer_load_dwordx4 v[60:63], v99, s[24:27], s99 offen sc1
    s_waitcnt vmcnt(0)
    v_xor_b32 v60, s36, v60
    v_xor_b32 v61, s37, v61
    v_xor_b32 v62, s38, v62
    v_xor_b32 v63, s39, v63
    v_or3_b32 v84, v60, v61, v62
    v_or_b32 v84, v84, v63
    v_and_b32 v84, 0xff, v84
    v_cmp_ne_u32 vcc, 0, v84
    s_nop 0
    s_bcnt0_i32_b64 s43, vcc
    s_lshr_b32 s43, s43, 1
    s_cmpk_lt_u32 s2, 96
    s_cselect_b32 s44, 10, 0
    s_add_u32 s43, s43, s44
    s_mul_i32 s44, s43, 1
    s_add_u32 s44, s44, 41
    s_max_u32 s45, s43, 38
    s_mul_i32 s45, s45, 1
    s_add_u32 s44, s44, s45
    s_cmp_gt_u32 s43, 10
    s_cselect_b32 s44, s44, 0
    v_mov_b32 v86, s44
    ds_max_u32 v94, v86 offset:96
    s_load_dword s92, s[86:87], 4096
    s_movk_i32 s99, 4096
    s_sub_u32 s46, s7, 4
    s_cmp_lt_u32 s46, 6
    s_cbranch_scc0 L_noh
    v_and_b32 v96, 3, v0
    v_bfe_u32 v97, v0, 2, 1
    v_lshl_or_b32 v96, v96, 1, v97
    v_mul_u32_u24 v96, 18432, v96
    v_and_b32 v97, 56, v0
    v_lshl_add_u32 v96, v97, 1, v96
    s_and_b32 s45, s2, 7
    s_mul_i32 s45, s45, 6
    s_add_u32 s45, s45, s46
    s_mul_i32 s45, s45, 384
    s_add_u32 s45, s45, 1179648
    s_add_u32 s44, s45, 147456
    buffer_load_dwordx4 v[104:107], v96, s[24:27], s45 offen offset:0 sc1
    buffer_load_dwordx4 v[108:111], v96, s[24:27], s45 offen offset:128 sc1
    buffer_load_dwordx4 v[112:115], v96, s[24:27], s45 offen offset:256 sc1
    buffer_load_dwordx4 v[116:119], v96, s[24:27], s44 offen offset:0 sc1
    buffer_load_dwordx4 v[120:123], v96, s[24:27], s44 offen offset:128 sc1
    buffer_load_dwordx4 v[124:127], v96, s[24:27], s44 offen offset:256 sc1
    s_waitcnt vmcnt(0)
    s_mov_b32 s47, 0
L_h_chk:
    v_xor_b32 v104, s36, v104
    v_xor_b32 v105, s37, v105
    v_xor_b32 v106, s38, v106
    v_xor_b32 v107, s39, v107
    v_xor_b32 v108, s36, v108
    v_xor_b32 v109, s37, v109
    v_xor_b32 v110, s38, v110
    v_xor_b32 v111, s39, v111
    v_xor_b32 v112, s36, v112
    v_xor_b32 v113, s37, v113
    v_xor_b32 v114, s38, v114
    v_xor_b32 v115, s39, v115
    v_xor_b32 v116, s36, v116
    v_xor_b32 v117, s37, v117
    v_xor_b32 v118, s38, v118
    v_xor_b32 v119, s39, v119
    v_xor_b32 v120, s36, v120
    v_xor_b32 v121, s37, v121
    v_xor_b32 v122, s38, v122
    v_xor_b32 v123, s39, v123
    v_xor_b32 v124, s36, v124
    v_xor_b32 v125, s37, v125
    v_xor_b32 v126, s38, v126
    v_xor_b32 v127, s39, v127
    v_or3_b32 v84, v104, v105, v106
    v_or3_b32 v84, v84, v107, v108
    v_or3_b32 v84, v84, v109, v110
    v_or3_b32 v84, v84, v111, v112
    v_or3_b32 v84, v84, v113, v114
    v_or3_b32 v84, v84, v115, v116
    v_or3_b32 v84, v84, v117, v118
    v_or3_b32 v84, v84, v119, v120
    v_or3_b32 v84, v84, v121, v122
    v_or3_b32 v84, v84, v123, v124
    v_or3_b32 v84, v84, v125, v126
    v_or_b32 v84, v84, v127
    v_and_b32 v84, 0xff, v84
    v_cmp_ne_u32 vcc, 0, v84
    s_cbranch_vccnz L_h_retry
L_h_ok:
    v_pk_add_f32 v[104:105], v[104:105], v[116:117]
    v_pk_add_f32 v[106:107], v[106:107], v[118:119]
    v_pk_add_f32 v[108:109], v[108:109], v[120:121]
    v_pk_add_f32 v[110:111], v[110:111], v[122:123]
    v_pk_add_f32 v[112:113], v[112:113], v[124:125]
    v_pk_add_f32 v[114:115], v[114:115], v[126:127]
    v_add_f32_dpp v104, v104, v104 quad_perm:[1,0,3,2] row_mask:0xf bank_mask:0xf
    v_add_f32_dpp v105, v105, v105 quad_perm:[1,0,3,2] row_mask:0xf bank_mask:0xf
    v_add_f32_dpp v106, v106, v106 quad_perm:[1,0,3,2] row_mask:0xf bank_mask:0xf
    v_add_f32_dpp v107, v107, v107 quad_perm:[1,0,3,2] row_mask:0xf bank_mask:0xf
    v_add_f32_dpp v108, v108, v108 quad_perm:[1,0,3,2] row_mask:0xf bank_mask:0xf
    v_add_f32_dpp v109, v109, v109 quad_perm:[1,0,3,2] row_mask:0xf bank_mask:0xf
    v_add_f32_dpp v110, v110, v110 quad_perm:[1,0,3,2] row_mask:0xf bank_mask:0xf
    v_add_f32_dpp v111, v111, v111 quad_perm:[1,0,3,2] row_mask:0xf bank_mask:0xf
    v_add_f32_dpp v112, v112, v112 quad_perm:[1,0,3,2] row_mask:0xf bank_mask:0xf
    v_add_f32_dpp v113, v113, v113 quad_perm:[1,0,3,2] row_mask:0xf bank_mask:0xf
    v_add_f32_dpp v114, v114, v114 quad_perm:[1,0,3,2] row_mask:0xf bank_mask:0xf
    v_add_f32_dpp v115, v115, v115 quad_perm:[1,0,3,2] row_mask:0xf bank_mask:0xf
    v_add_f32_dpp v104, v104, v104 quad_perm:[2,3,0,1] row_mask:0xf bank_mask:0xf
    v_add_f32_dpp v105, v105, v105 quad_perm:[2,3,0,1] row_mask:0xf bank_mask:0xf
    v_add_f32_dpp v106, v106, v106 quad_perm:[2,3,0,1] row_mask:0xf bank_mask:0xf
    v_add_f32_dpp v107, v107, v107 quad_perm:[2,3,0,1] row_mask:0xf bank_mask:0xf
    v_add_f32_dpp v108, v108, v108 quad_perm:[2,3,0,1] row_mask:0xf bank_mask:0xf
    v_add_f32_dpp v109, v109, v109 quad_perm:[2,3,0,1] row_mask:0xf bank_mask:0xf
    v_add_f32_dpp v110, v110, v110 quad_perm:[2,3,0,1] row_mask:0xf bank_mask:0xf
    v_add_f32_dpp v111, v111, v111 quad_perm:[2,3,0,1] row_mask:0xf bank_mask:0xf
    v_add_f32_dpp v112, v112, v112 quad_perm:[2,3,0,1] row_mask:0xf bank_mask:0xf
    v_add_f32_dpp v113, v113, v113 quad_perm:[2,3,0,1] row_mask:0xf bank_mask:0xf
    v_add_f32_dpp v114, v114, v114 quad_perm:[2,3,0,1] row_mask:0xf bank_mask:0xf
    v_add_f32_dpp v115, v115, v115 quad_perm:[2,3,0,1] row_mask:0xf bank_mask:0xf
    v_cvt_pk_bf16_f32 v104, v104, v104
    v_cvt_pk_bf16_f32 v105, v105, v105
    v_cvt_pk_bf16_f32 v106, v106, v106
    v_cvt_pk_bf16_f32 v107, v107, v107
    v_cvt_pk_bf16_f32 v108, v108, v108
    v_cvt_pk_bf16_f32 v109, v109, v109
    v_cvt_pk_bf16_f32 v110, v110, v110
    v_cvt_pk_bf16_f32 v111, v111, v111
    v_cvt_pk_bf16_f32 v112, v112, v112
    v_cvt_pk_bf16_f32 v113, v113, v113
    v_cvt_pk_bf16_f32 v114, v114, v114
    v_cvt_pk_bf16_f32 v115, v115, v115
    v_and_b32 v104, 0xffff0000, v104
    v_and_b32 v105, 0xffff0000, v105
    v_and_b32 v106, 0xffff0000, v106
    v_and_b32 v107, 0xffff0000, v107
    v_and_b32 v108, 0xffff0000, v108
    v_and_b32 v109, 0xffff0000, v109
    v_and_b32 v110, 0xffff0000, v110
    v_and_b32 v111, 0xffff0000, v111
    v_and_b32 v112, 0xffff0000, v112
    v_and_b32 v113, 0xffff0000, v113
    v_and_b32 v114, 0xffff0000, v114
    v_and_b32 v115, 0xffff0000, v115
    v_mov_b32_dpp v128, v104 row_half_mirror row_mask:0xf bank_mask:0xf
    v_mov_b32_dpp v129, v105 row_half_mirror row_mask:0xf bank_mask:0xf
    v_mov_b32_dpp v130, v106 row_half_mirror row_mask:0xf bank_mask:0xf
    v_mov_b32_dpp v131, v107 row_half_mirror row_mask:0xf bank_mask:0xf
    v_mov_b32_dpp v132, v108 row_half_mirror row_mask:0xf bank_mask:0xf
    v_mov_b32_dpp v133, v109 row_half_mirror row_mask:0xf bank_mask:0xf
    v_mov_b32_dpp v134, v110 row_half_mirror row_mask:0xf bank_mask:0xf
    v_mov_b32_dpp v135, v111 row_half_mirror row_mask:0xf bank_mask:0xf
    v_mov_b32_dpp v136, v112 row_half_mirror row_mask:0xf bank_mask:0xf
    v_mov_b32_dpp v137, v113 row_half_mirror row_mask:0xf bank_mask:0xf
    v_mov_b32_dpp v138, v114 row_half_mirror row_mask:0xf bank_mask:0xf
    v_mov_b32_dpp v139, v115 row_half_mirror row_mask:0xf bank_mask:0xf
    v_mul_f32 v140, 0xbfb8aa3b, v104
    v_mul_f32 v141, 0xbfb8aa3b, v105
    v_mul_f32 v142, 0xbfb8aa3b, v106
    v_mul_f32 v143, 0xbfb8aa3b, v107
    v_mul_f32 v144, 0xbfb8aa3b, v108
    v_mul_f32 v145, 0xbfb8aa3b, v109
    v_mul_f32 v146, 0xbfb8aa3b, v110
    v_mul_f32 v147, 0xbfb8aa3b, v111
    v_mul_f32 v148, 0xbfb8aa3b, v112
    v_mul_f32 v149, 0xbfb8aa3b, v113
    v_mul_f32 v150, 0xbfb8aa3b, v114
    v_mul_f32 v151, 0xbfb8aa3b, v115
    v_exp_f32 v140, v140
    v_exp_f32 v141, v141
    v_exp_f32 v142, v142
    v_exp_f32 v143, v143
    v_exp_f32 v144, v144
    v_exp_f32 v145, v145
    v_exp_f32 v146, v146
    v_exp_f32 v147, v147
    v_exp_f32 v148, v148
    v_exp_f32 v149, v149
    v_exp_f32 v150, v150
    v_exp_f32 v151, v151
    v_add_f32 v140, 1.0, v140
    v_add_f32 v141, 1.0, v141
    v_add_f32 v142, 1.0, v142
    v_add_f32 v143, 1.0, v143
    v_add_f32 v144, 1.0, v144
    v_add_f32 v145, 1.0, v145
    v_add_f32 v146, 1.0, v146
    v_add_f32 v147, 1.0, v147
    v_add_f32 v148, 1.0, v148
    v_add_f32 v149, 1.0, v149
    v_add_f32 v150, 1.0, v150
    v_add_f32 v151, 1.0, v151
    v_rcp_f32 v140, v140
    v_rcp_f32 v141, v141
    v_rcp_f32 v142, v142
    v_rcp_f32 v143, v143
    v_rcp_f32 v144, v144
    v_rcp_f32 v145, v145
    v_rcp_f32 v146, v146
    v_rcp_f32 v147, v147
    v_rcp_f32 v148, v148
    v_rcp_f32 v149, v149
    v_rcp_f32 v150, v150
    v_rcp_f32 v151, v151
    v_mul_f32 v140, v104, v140
    v_mul_f32 v141, v105, v141
    v_mul_f32 v142, v106, v142
    v_mul_f32 v143, v107, v143
    v_mul_f32 v144, v108, v144
    v_mul_f32 v145, v109, v145
    v_mul_f32 v146, v110, v146
    v_mul_f32 v147, v111, v147
    v_mul_f32 v148, v112, v148
    v_mul_f32 v149, v113, v149
    v_mul_f32 v150, v114, v150
    v_mul_f32 v151, v115, v151
    v_cvt_pk_bf16_f32 v140, v140, v140
    v_cvt_pk_bf16_f32 v141, v141, v141
    v_cvt_pk_bf16_f32 v142, v142, v142
    v_cvt_pk_bf16_f32 v143, v143, v143
    v_cvt_pk_bf16_f32 v144, v144, v144
    v_cvt_pk_bf16_f32 v145, v145, v145
    v_cvt_pk_bf16_f32 v146, v146, v146
    v_cvt_pk_bf16_f32 v147, v147, v147
    v_cvt_pk_bf16_f32 v148, v148, v148
    v_cvt_pk_bf16_f32 v149, v149, v149
    v_cvt_pk_bf16_f32 v150, v150, v150
    v_cvt_pk_bf16_f32 v151, v151, v151
    v_and_b32 v140, 0xffff0000, v140
    v_and_b32 v141, 0xffff0000, v141
    v_and_b32 v142, 0xffff0000, v142
    v_and_b32 v143, 0xffff0000, v143
    v_and_b32 v144, 0xffff0000, v144
    v_and_b32 v145, 0xffff0000, v145
    v_and_b32 v146, 0xffff0000, v146
    v_and_b32 v147, 0xffff0000, v147
    v_and_b32 v148, 0xffff0000, v148
    v_and_b32 v149, 0xffff0000, v149
    v_and_b32 v150, 0xffff0000, v150
    v_and_b32 v151, 0xffff0000, v151
    v_mul_f32 v140, v140, v128
    v_mul_f32 v141, v141, v129
    v_mul_f32 v142, v142, v130
    v_mul_f32 v143, v143, v131
    v_mul_f32 v144, v144, v132
    v_mul_f32 v145, v145, v133
    v_mul_f32 v146, v146, v134
    v_mul_f32 v147, v147, v135
    v_mul_f32 v148, v148, v136
    v_mul_f32 v149, v149, v137
    v_mul_f32 v150, v150, v138
    v_mul_f32 v151, v151, v139
    v_cvt_pk_bf16_f32 v104, v140, v141
    v_cvt_pk_bf16_f32 v105, v142, v143
    v_cvt_pk_bf16_f32 v106, v144, v145
    v_cvt_pk_bf16_f32 v107, v146, v147
    v_cvt_pk_bf16_f32 v108, v148, v149
    v_cvt_pk_bf16_f32 v109, v150, v151
    s_mov_b32 exec_lo, 0x01010101
    s_mov_b32 exec_hi, 0x01010101
    ds_write_b64 v97, v[104:105] offset:256
    ds_write_b64 v97, v[106:107] offset:320
    ds_write_b64 v97, v[108:109] offset:384
    s_mov_b64 exec, -1
L_noh:
    buffer_load_dwordx4 v[60:63], v100, s[24:27], s51 offen sc1
    buffer_load_dwordx4 v[72:75], v94, s[24:27], s99 offen sc1
    s_waitcnt vmcnt(0)
    s_mov_b32 s47, 0
L_ml_chk:
    v_xor_b32 v60, s36, v60
    v_xor_b32 v61, s37, v61
    v_xor_b32 v62, s38, v62
    v_xor_b32 v63, s39, v63
    v_xor_b32 v72, s36, v72
    v_xor_b32 v73, s37, v73
    v_xor_b32 v74, s38, v74
    v_xor_b32 v75, s39, v75
    v_or3_b32 v84, v60, v61, v62
    v_or3_b32 v84, v84, v63, v72
    v_or3_b32 v84, v84, v73, v74
    v_or_b32 v84, v84, v75
    v_and_b32 v84, 0xff, v84
    v_cmp_ne_u32 vcc, 0, v84
    s_cbranch_vccnz L_ml_retry
L_ml_ok:
    v_and_b32 v72, 0x2000, v72
    ds_write_b32 v94, v72 offset:80
    v_mov_b32 v64, v60
    v_mov_b32 v66, v62
    s_nop 0
    v_max_f32_dpp v64, v64, v64 row_ror:8 row_mask:0xf bank_mask:0xf
    v_max_f32_dpp v66, v66, v66 row_ror:8 row_mask:0xf bank_mask:0xf
    s_nop 0
    v_max_f32_dpp v64, v64, v64 row_ror:4 row_mask:0xf bank_mask:0xf
    v_max_f32_dpp v66, v66, v66 row_ror:4 row_mask:0xf bank_mask:0xf
    s_nop 0
    v_max_f32_dpp v64, v64, v64 row_ror:2 row_mask:0xf bank_mask:0xf
    v_max_f32_dpp v66, v66, v66 row_ror:2 row_mask:0xf bank_mask:0xf
    s_nop 0
    v_max_f32_dpp v64, v64, v64 row_ror:1 row_mask:0xf bank_mask:0xf
    v_max_f32_dpp v66, v66, v66 row_ror:1 row_mask:0xf bank_mask:0xf
    v_mov_b32 v68, v64
    v_mov_b32 v69, v66
    s_nop 0
    v_permlane16_swap_b32 v64, v68
    v_permlane16_swap_b32 v66, v69
    v_max_f32 v64, v64, v68
    v_max_f32 v66, v66, v69
    v_mov_b32 v68, v64
    v_mov_b32 v69, v66
    s_nop 0
    v_permlane32_swap_b32 v64, v68
    v_permlane32_swap_b32 v66, v69
    v_max_f32 v64, v64, v68
    v_max_f32 v66, v66, v69
    v_sub_f32 v60, v60, v64
    v_sub_f32 v62, v62, v66
    v_mul_f32 v60, 0x3fb8aa3b, v60
    v_mul_f32 v62, 0x3fb8aa3b, v62
    v_exp_f32 v60, v60
    v_exp_f32 v62, v62
    v_mul_f32 v60, v60, v61
    v_mul_f32 v62, v62, v63
    s_nop 0
    v_add_f32_dpp v60, v60, v60 row_ror:8 row_mask:0xf bank_mask:0xf
    v_add_f32_dpp v62, v62, v62 row_ror:8 row_mask:0xf bank_mask:0xf
    s_nop 0
    v_add_f32_dpp v60, v60, v60 row_ror:4 row_mask:0xf bank_mask:0xf
    v_add_f32_dpp v62, v62, v62 row_ror:4 row_mask:0xf bank_mask:0xf
    s_nop 0
    v_add_f32_dpp v60, v60, v60 row_ror:2 row_mask:0xf bank_mask:0xf
    v_add_f32_dpp v62, v62, v62 row_ror:2 row_mask:0xf bank_mask:0xf
    s_nop 0
    v_add_f32_dpp v60, v60, v60 row_ror:1 row_mask:0xf bank_mask:0xf
    v_add_f32_dpp v62, v62, v62 row_ror:1 row_mask:0xf bank_mask:0xf
    v_mov_b32 v68, v60
    v_mov_b32 v69, v62
    s_nop 0
    v_permlane16_swap_b32 v60, v68
    v_permlane16_swap_b32 v62, v69
    v_add_f32 v60, v60, v68
    v_add_f32 v62, v62, v69
    v_mov_b32 v68, v60
    v_mov_b32 v69, v62
    s_nop 0
    v_permlane32_swap_b32 v60, v68
    v_permlane32_swap_b32 v62, v69
    v_add_f32 v60, v60, v68
    v_add_f32 v62, v62, v69
    v_rcp_f32 v65, v60
    v_rcp_f32 v67, v62
    s_nop 0
    ds_write_b128 v94, v[64:67] offset:64
    s_lshl4_add_u32 s43, s4, s5
    s_lshl_b32 s43, s43, 10
    s_add_u32 s43, s43, 262144
    s_cmp_eq_u32 s98, 0
    s_waitcnt lgkmcnt(0)
    s_barrier
    ds_read_b128 v[60:63], v1 offset:1024
    ds_read_b128 v[64:67], v1 offset:2048
    ds_read_b128 v[68:71], v1 offset:3072
    ds_read_b128 v[72:75], v1 offset:4096
    s_waitcnt lgkmcnt(2)
    v_pk_add_f32 v[60:61], v[60:61], v[64:65]
    v_pk_add_f32 v[62:63], v[62:63], v[66:67]
    s_waitcnt lgkmcnt(0)
    v_pk_add_f32 v[68:69], v[68:69], v[72:73]
    v_pk_add_f32 v[70:71], v[70:71], v[74:75]
    v_pk_add_f32 v[20:21], v[60:61], v[68:69]
    v_pk_add_f32 v[22:23], v[62:63], v[70:71]
    v_and_or_b32 v20, v20, v2, s36
    v_and_or_b32 v21, v21, v2, s37
    v_and_or_b32 v22, v22, v2, s38
    v_and_or_b32 v23, v23, v2, s39
    s_cbranch_scc0 L_op_far
    buffer_store_dwordx4 v[20:23], v39, s[24:27], s43 offen
L_op_sd:
    s_barrier
    s_cmp_lt_u32 s6, 12
    s_cbranch_scc0 L_fin
    s_barrier
L_fin:
    s_endpgm
L_fl_retry:
    s_add_u32 s47, s47, 1
    s_cmp_ge_u32 s47, 131072
    s_cbranch_scc1 L_fl_ok
    s_sleep 1
    ds_read_b64 v[84:85], v100 offset:64
    ds_read_b32 v86, v99 offset:0
    ds_read_b32 v87, v91 offset:80
    s_waitcnt lgkmcnt(0)
    s_branch L_fl_chk
L_q_retry:
    s_add_u32 s47, s47, 1
    s_cmp_ge_u32 s47, 131072
    s_cbranch_scc1 L_q_ok
    s_sleep 2
    s_cmp_eq_u32 s47, 16
    s_cbranch_scc0 L_q_nto
    buffer_store_dwordx4 v[20:23], v98, s[24:27], s50 offen sc1
L_q_nto:
    buffer_load_dwordx4 v[60:63], v1, s[24:27], s51 offen offset:0 sc1
    buffer_load_dwordx4 v[64:67], v1, s[24:27], s51 offen offset:1024 sc1
    buffer_load_dwordx4 v[68:71], v1, s[24:27], s51 offen offset:2048 sc1
    buffer_load_dwordx4 v[72:75], v1, s[24:27], s51 offen offset:3072 sc1
    buffer_load_dwordx4 v[44:47], v99, s[24:27], s99 offen sc1
    s_waitcnt vmcnt(0)
    s_branch L_q_chk
L_q_far:
    buffer_store_dwordx4 v[20:23], v98, s[24:27], s50 offen sc1
    s_branch L_q_sd
L_gu_far:
    buffer_store_dwordx4 v[24:27], v95, s[24:27], s43 offen sc1
    s_branch L_gu_sd
L_g5_far:
    buffer_store_dwordx4 v[48:51], v98, s[24:27], s43 offen offset:1024 sc1
    s_branch L_g5_sd
L_mw_retry:
    s_add_u32 s47, s47, 1
    s_cmp_ge_u32 s47, 131072
    s_cbranch_scc1 L_mw_ok
    s_sleep 4
    ds_read_b128 v[60:63], v64 offset:0
    s_waitcnt lgkmcnt(0)
    s_branch L_mw_chk
L_mp_far:
    buffer_store_dwordx4 v[68:71], v1, s[24:27], s43 offen sc1
    s_branch L_mp_sd
L_h_retry:
    s_add_u32 s47, s47, 1
    s_cmp_ge_u32 s47, 131072
    s_cbranch_scc1 L_h_ok
    s_sleep 8
    buffer_load_dwordx4 v[104:107], v96, s[24:27], s45 offen offset:0 sc1
    buffer_load_dwordx4 v[108:111], v96, s[24:27], s45 offen offset:128 sc1
    buffer_load_dwordx4 v[112:115], v96, s[24:27], s45 offen offset:256 sc1
    buffer_load_dwordx4 v[116:119], v96, s[24:27], s44 offen offset:0 sc1
    buffer_load_dwordx4 v[120:123], v96, s[24:27], s44 offen offset:128 sc1
    buffer_load_dwordx4 v[124:127], v96, s[24:27], s44 offen offset:256 sc1
    s_waitcnt vmcnt(0)
    s_branch L_h_chk
L_ml_retry:
    s_add_u32 s47, s47, 1
    s_cmp_ge_u32 s47, 131072
    s_cbranch_scc1 L_ml_ok
    s_sleep 16
    buffer_load_dwordx4 v[60:63], v100, s[24:27], s51 offen sc1
    buffer_load_dwordx4 v[72:75], v94, s[24:27], s99 offen sc1
    s_waitcnt vmcnt(0)
    s_branch L_ml_chk
L_op_far:
    buffer_store_dwordx4 v[20:23], v39, s[24:27], s43 offen sc1
    s_branch L_op_sd
L_end:
    s_endpgm
.section .rodata,"a"
.p2align 6
.amdhsa_kernel parallel_sum__gqa_block_cached__swiglu_ffn__decode_kernel
  .amdhsa_next_free_vgpr 248
  .amdhsa_next_free_sgpr 100
  .amdhsa_accum_offset 248
  .amdhsa_group_segment_fixed_size 0
  .amdhsa_kernarg_size 96
  .amdhsa_user_sgpr_count 2
  .amdhsa_user_sgpr_kernarg_segment_ptr 1
  .amdhsa_system_sgpr_workgroup_id_x 1
  .amdhsa_float_denorm_mode_32 3
.end_amdhsa_kernel
```
